```python
import torch

def _softmax(x, axis=-1):
    return torch.softmax(x, dim=axis)
def _gelu(x):
    return torch.nn.functional.gelu(x, approximate="tanh")
def _silu(x):
    return torch.nn.functional.silu(x)
def _sigmoid(x):
    return torch.sigmoid(x)
def _layernorm(x, axis=-1, eps=1e-5):
    m = x.mean(dim=axis, keepdim=True)
    v = x.var(dim=axis, keepdim=True, unbiased=False)
    return (x - m) / torch.sqrt(v + eps)
def _scatter_add(tgt, idx, src, axis=0):
    return tgt.clone().index_add_(axis, idx, src)
def _segment_sum(src, seg, n):
    out = torch.zeros((n,) + src.shape[1:], dtype=src.dtype)
    return out.index_add_(0, seg, src)
def _pad(x, pw):
    flat = tuple(v for pair in reversed(pw) for v in pair)
    return torch.nn.functional.pad(x, flat)

kernel_name = 'interleave_layers__sliding_block_cached__glu_gated_swiglu__decode'

def setup_inputs():

    _w = (lambda a: (lambda t: t.to(torch.bfloat16) if t.is_floating_point() else t)(torch.as_tensor(a)))
    def _A_setup():
        B, Sq, D = 4, 1, 512
        Hq, Hkv, Sk, Dh = 32, 8, 4096, 128
        assert Hq % Hkv == 0, (Hq, Hkv)
        return {
            "x": _w((lambda *s: torch.randn(*s, dtype=torch.bfloat16) * 0.05)(B, Sq, D)),
            "k_cache": _w((lambda *s: torch.randn(*s, dtype=torch.bfloat16) * 0.8)(B, Hkv, Sk, Dh)),
            "v_cache": _w((lambda *s: torch.randn(*s, dtype=torch.bfloat16) * 0.8)(B, Hkv, Sk, Dh)),
            "wq": _w((lambda *s: torch.randn(*s, dtype=torch.bfloat16) * 0.8)(D, Hq * Dh) * (D ** -0.5)),
            "wo": _w((lambda *s: torch.randn(*s, dtype=torch.bfloat16) * 0.8)(Hq * Dh, D) * ((Hq * Dh) ** -0.5)),
        }
    _A_in = _A_setup()

    def _B_setup():
        B, S, D, F = 4, 1, 512, 1792
        return {
            "x": _w((lambda *s: torch.randn(*s, dtype=torch.bfloat16) * 0.05)(B, S, D)),
            "w1": _w((lambda *s: torch.randn(*s, dtype=torch.bfloat16) * 0.2)(D, F) * (2.0 / D) ** 0.5),
            "w3": _w((lambda *s: torch.randn(*s, dtype=torch.bfloat16) * 0.2)(D, F) * (2.0 / D) ** 0.5),
            "w2": _w((lambda *s: torch.randn(*s, dtype=torch.bfloat16) * 0.2)(F, D) * (2.0 / F) ** 0.5),
        }
    _B_in = _B_setup()

    return {
        "A_x": _A_in["x"],
        "A_k_cache": _A_in["k_cache"],
        "A_v_cache": _A_in["v_cache"],
        "A_wq": _A_in["wq"],
        "A_wo": _A_in["wo"],
        "B_x": _B_in["x"],
        "B_w1": _B_in["w1"],
        "B_w3": _B_in["w3"],
        "B_w2": _B_in["w2"],
    }

def reference(A_x, A_k_cache, A_v_cache, A_wq, A_wo, B_x, B_w1, B_w3, B_w2):
    def _A_ref(x, k_cache, v_cache, wq, wo):
        B, Sq, D = x.shape
        Hq, Dh = 32, 128
        Hkv, Sk = k_cache.shape[1], k_cache.shape[2]
        W = min(4096, max(256, Sk // 4))
        rep = Hq // Hkv
        q = (lambda x, *d: x.permute(*d))((x @ wq).reshape(B, Sq, Hq, Dh), 0, 2, 1, 3)
        k = (lambda x, n, axis: torch.repeat_interleave(x, n, dim=axis))(k_cache[:, :, Sk - W:, :], rep, axis=1)
        v = (lambda x, n, axis: torch.repeat_interleave(x, n, dim=axis))(v_cache[:, :, Sk - W:, :], rep, axis=1)
        scores = torch.einsum("bhqd,bhkd->bhqk", q, k) * (Dh ** -0.5)
        p = _softmax(scores, axis=-1)
        o = torch.einsum("bhqk,bhkd->bhqd", p, v)
        return (lambda x, *d: x.permute(*d))(o, 0, 2, 1, 3).reshape(B, Sq, Hq * Dh) @ wo

    def _B_ref(x, w1, w3, w2):
        gate = torch.einsum("bsd,df->bsf", x, w1)
        up = torch.einsum("bsd,df->bsf", x, w3)
        h = _silu(gate) * up
        out = torch.einsum("bsf,fd->bsd", h, w2)
        return out

    x = A_x
    x = x + _A_ref(_layernorm(x, axis=-1), A_k_cache, A_v_cache, A_wq, A_wo)
    x = x + _B_ref(_layernorm(x, axis=-1), B_w1, B_w3, B_w2)
    x = x + _A_ref(_layernorm(x, axis=-1), A_k_cache, A_v_cache, A_wq, A_wo)
    x = x + _B_ref(_layernorm(x, axis=-1), B_w1, B_w3, B_w2)
    return x
```

```asm
; @launch grid=(256,1,1) block=(320,1,1) lds=134208
.amdgcn_target "amdgcn-amd-amdhsa--gfx950"
.text
.p2align 12
.globl interleave_layers__sliding_block_cached__glu_gated_swiglu__decode_kernel
.p2align 8
.type interleave_layers__sliding_block_cached__glu_gated_swiglu__decode_kernel,@function
interleave_layers__sliding_block_cached__glu_gated_swiglu__decode_kernel:
    s_load_dwordx16 s[16:31], s[0:1], 0
    s_load_dwordx8 s[32:39], s[0:1], 64
    s_cmp_ge_u32 s2, 256
    s_cbranch_scc1 L_end
    v_lshrrev_b32 v64, 6, v0
    s_lshr_b32 s4, s2, 3
    v_readfirstlane_b32 s5, v64
    v_and_b32 v1, 63, v0
    s_and_b32 s3, s2, 7
    s_cmp_eq_u32 s5, 4
    s_cbranch_scc1 L_loader
    s_barrier
    s_branch L_main
L_loader:
    s_setprio 3
    s_memrealtime s[40:41]
    s_getpc_b64 s[10:11]
L_pc:
    v_and_b32 v64, 15, v1
    v_lshlrev_b32 v65, 7, v64
    s_and_b32 s14, s4, 7
    s_lshl_b32 s9, s14, 11
    v_add_u32 v66, s9, v65
    v_min_u32 v66, L_codeend-L_pc+2048, v66
    global_load_dword v61, v66, s[10:11]
    v_mov_b32 v59, 134144
    v_mov_b64 v[72:73], 0
    v_mov_b64 v[74:75], 0
    ds_write_b128 v59, v[72:75] offset:16
    ds_write_b128 v59, v[72:75]
    v_lshrrev_b32 v67, 3, v1
    v_and_b32 v69, 7, v1
    v_and_b32 v68, 2, v67
    v_xor_b32 v68, v68, v69
    v_lshlrev_b32 v68, 4, v68
    s_and_b32 s7, s4, 3
    s_lshr_b32 s15, s4, 3
    s_lshl_b32 s9, s7, 20
    s_lshr_b32 s10, s4, 2
    s_lshl_b32 s10, s10, 7
    s_lshl_b32 s11, s3, 10
    s_add_u32 s9, s9, s10
    s_add_u32 s9, s9, s11
    v_lshl_add_u32 v70, v67, 13, v68
    v_add_u32 v70, s9, v70
    v_xor_b32 v71, 64, v70
    v_lshlrev_b32 v76, 4, v1
    s_lshl_b32 s52, s3, 18
    s_add_u32 s52, s52, 0x100000
    s_mul_i32 s9, s4, 1152
    s_add_u32 s9, s9, s52
    v_min_u32 v66, 1024, v65
    v_add_u32 v66, s9, v66
    s_lshl_b32 s9, s4, 11
    s_add_u32 s9, s9, s52
    s_add_u32 s9, s9, 0x18000
    v_add_u32 v77, s9, v76
    v_mov_b64 v[72:73], -1
    v_mov_b64 v[74:75], -1
    s_mov_b32 m0, 130048
    s_waitcnt lgkmcnt(0)
    s_barrier
    global_load_lds_dwordx4 v76, s[16:17] offset:0
    global_load_lds_dwordx4 v76, s[16:17] offset:1024
    global_load_lds_dwordx4 v76, s[16:17] offset:2048
    global_load_lds_dwordx4 v76, s[16:17] offset:3072
    global_load_dword v61, v66, s[38:39] sc1
    global_store_dwordx4 v77, v[72:75], s[38:39]
    global_store_dwordx4 v77, v[72:75], s[38:39] offset:1024
    s_mov_b32 m0, 65536
    s_nop 0
    global_load_lds_dwordx4 v70, s[22:23] nt
    s_mov_b32 m0, 66560
    v_add_u32 v70, 0x10000, v70
    global_load_lds_dwordx4 v70, s[22:23] nt
    s_mov_b32 m0, 67584
    v_add_u32 v70, 0x10000, v70
    global_load_lds_dwordx4 v70, s[22:23] nt
    s_mov_b32 m0, 68608
    v_add_u32 v70, 0x10000, v70
    global_load_lds_dwordx4 v70, s[22:23] nt
    s_mov_b32 m0, 69632
    v_add_u32 v71, 0x40000, v71
    global_load_lds_dwordx4 v71, s[22:23] nt
    s_mov_b32 m0, 70656
    v_add_u32 v71, 0x10000, v71
    global_load_lds_dwordx4 v71, s[22:23] nt
    s_mov_b32 m0, 71680
    v_add_u32 v71, 0x10000, v71
    global_load_lds_dwordx4 v71, s[22:23] nt
    s_mov_b32 m0, 72704
    v_add_u32 v71, 0x10000, v71
    global_load_lds_dwordx4 v71, s[22:23] nt
    s_mov_b32 m0, 73728
    v_add_u32 v70, 0x50000, v70
    global_load_lds_dwordx4 v70, s[22:23] nt
    s_mov_b32 m0, 74752
    v_add_u32 v70, 0x10000, v70
    global_load_lds_dwordx4 v70, s[22:23] nt
    s_mov_b32 m0, 75776
    v_add_u32 v70, 0x10000, v70
    global_load_lds_dwordx4 v70, s[22:23] nt
    s_mov_b32 m0, 76800
    v_add_u32 v70, 0x10000, v70
    global_load_lds_dwordx4 v70, s[22:23] nt
    s_mov_b32 m0, 77824
    v_add_u32 v71, 0x50000, v71
    s_branch L_ld2
L_main:
    s_waitcnt lgkmcnt(0)
    s_load_dword s6, s[38:39], 0
    s_lshr_b32 s9, s2, 4
    s_lshl_b32 s9, s9, 15
    s_and_b32 s10, s2, 15
    s_lshl_b32 s10, s10, 2
    s_add_u32 s10, s10, s5
    s_lshl_b32 s10, s10, 7
    s_add_u32 s9, s9, s10
    s_add_u32 s9, s9, 0x504000
    s_add_u32 s60, s38, s9
    s_addc_u32 s61, s39, 0
    s_xor_b32 s9, s9, 2048
    s_add_u32 s10, s9, 0x2000
    s_load_dword s59, s[38:39], s9
    s_load_dword s59, s[38:39], s10
    v_and_b32 v48, 7, v1
    v_lshrrev_b32 v49, 5, v1
    v_lshrrev_b32 v50, 4, v1
    v_and_b32 v51, 15, v1
    s_and_b32 s7, s4, 3
    s_lshr_b32 s15, s4, 3
    v_lshlrev_b32 v4, 4, v0
    v_mov_b32 v59, 134144
    s_mov_b32 s8, 400000
    s_movk_i32 s12, 0xff
    s_mov_b32 s51, 0x3f803f80
    s_mov_b32 s13, 0
    s_getreg_b32 s50, hwreg(HW_REG_XCC_ID, 0, 4)
    s_lshl_b32 s11, s3, 18
    s_add_u32 s11, s11, 0x100000
    s_add_u32 s44, s38, s11
    s_addc_u32 s45, s39, 0
    s_mov_b32 s46, 0x40000
    s_mov_b32 s47, 0x20000
    v_and_b32 v52, 3, v1
    v_bfe_u32 v53, v1, 2, 2
    v_lshlrev_b32 v54, 4, v1
    v_mov_b32 v55, 0x7ff00000
    v_and_b32 v80, 1, v52
    v_lshlrev_b32 v80, 3, v80
    s_lshl_b32 s10, s5, 1
    v_lshrrev_b32 v79, 1, v52
    v_add_u32 v79, s10, v79
    v_lshrrev_b32 v81, 1, v53
    v_and_b32 v82, 1, v53
    v_and_b32 v84, 1, v50
    v_lshl_or_b32 v85, v84, 1, v81
    v_lshlrev_b32 v86, 1, v85
    v_xor_b32 v86, v86, v79
    v_lshl_add_u32 v86, v86, 4, v80
    v_lshl_add_u32 v86, v53, 7, v86
    v_lshl_add_u32 v56, v50, 12, v86
    v_add_u32 v56, 65536, v56
    v_lshl_add_u32 v86, v50, 11, v86
    v_add_u32 v58, 114688, v86
    v_lshl_or_b32 v85, v82, 1, v84
    v_lshlrev_b32 v85, 1, v85
    v_xor_b32 v85, v85, v79
    v_lshl_add_u32 v85, v85, 4, v80
    v_lshl_add_u32 v86, v84, 2, v81
    v_lshl_add_u32 v85, v86, 7, v85
    v_lshl_add_u32 v86, v82, 1, v49
    v_lshl_add_u32 v85, v86, 12, v85
    v_add_u32 v57, 81920, v85
    v_lshl_or_b32 v85, v84, 1, v82
    v_lshl_or_b32 v85, v81, 2, v85
    v_xor_b32 v85, s10, v85
    v_lshlrev_b32 v85, 5, v85
    v_lshl_add_u32 v85, v52, 3, v85
    v_lshl_add_u32 v86, v50, 2, v82
    v_lshl_add_u32 v86, v81, 5, v86
    v_lshl_add_u32 v85, v86, 8, v85
    v_add_u32 v45, 32768, v85
    s_lshl_b32 s9, s7, 8
    v_lshlrev_b32 v85, 10, v53
    v_lshl_add_u32 v85, v50, 6, v85
    v_lshl_add_u32 v85, v52, 4, v85
    v_add_u32 v2, s9, v85
    s_lshl_b32 s11, s15, 10
    v_add_u32 v3, s11, v54
    s_lshl_b32 s11, s4, 5
    v_lshlrev_b32 v85, 10, v50
    v_lshl_add_u32 v85, v48, 2, v85
    v_add_u32 v254, s11, v85
    v_add_u32 v88, 130048, v2
    v_add_u32 v89, 130048, v3
    v_add_u32 v90, 130048, v254
    s_lshr_b32 s14, s4, 2
    s_lshl_b32 s10, s5, 6
    s_lshl_b32 s11, s7, 3
    s_add_u32 s11, s11, s14
    s_lshl_b32 s11, s11, 8
    s_add_u32 s11, s11, s10
    s_add_u32 s11, s11, 0x1000
    v_cmp_eq_u32 vcc, 0, v52
    v_lshlrev_b32 v86, 4, v50
    v_lshl_add_u32 v85, v53, 13, v86
    v_add_u32 v85, s11, v85
    v_cndmask_b32 v5, v55, v85, vcc
    s_mul_i32 s11, s14, 5120
    s_add_u32 s11, s11, s10
    s_add_u32 s11, s11, s9
    s_add_u32 s11, s11, 0xe000
    v_lshl_add_u32 v85, v53, 10, v86
    v_add_u32 v85, s11, v85
    v_cndmask_b32 v6, v55, v85, vcc
    v_cmp_eq_u32 vcc, 0, v51
    v_add_u32 v85, 32768, v5
    s_nop 0
    v_cndmask_b32 v118, v55, v85, vcc
    v_add_u32 v85, 4096, v6
    v_cndmask_b32 v46, v55, v85, vcc
    s_lshl_b32 s10, s4, 3
    s_add_u32 s10, s10, 0x0
    v_mov_b32 v85, s10
    v_cmp_eq_u32 vcc, 0, v0
    s_nop 1
    v_cndmask_b32 v116, v55, v85, vcc
    v_and_b32 v86, 0x1f0, v54
    v_lshrrev_b32 v117, 1, v86
    v_add_u32 v117, 0x0, v117
    s_lshl_b32 s10, s15, 13
    s_lshl_b32 s11, s5, 9
    s_add_u32 s10, s10, s11
    s_add_u32 s10, s10, 0x1000
    v_lshl_add_u32 v85, v49, 12, v86
    v_add_u32 v7, s10, v85
    s_mul_i32 s10, s4, 384
    s_add_u32 s10, s10, 0xb000
    v_add_u32 v85, s10, v4
    v_cmp_gt_u32 vcc, 24, v0
    s_nop 1
    v_cndmask_b32 v60, v55, v85, vcc
    v_mov_b32 v100, s51
    v_mov_b32 v112, -1
    v_mov_b32 v101, s51
    v_mov_b32 v113, -1
    v_mov_b32 v102, s51
    v_mov_b32 v114, -1
    v_mov_b32 v103, s51
    v_mov_b32 v115, -1
L_sx:
    s_mov_b64 exec, 1
    ds_read_b32 v64, v59 offset:16
    s_mov_b64 exec, -1
    s_sub_u32 s8, s8, 1
    s_cbranch_scc1 L_end
    s_waitcnt lgkmcnt(0)
    v_readfirstlane_b32 s9, v64
    s_cmp_lt_u32 s9, 1
    s_cbranch_scc1 L_sx
    s_add_u32 s6, s6, 1
    v_mov_b32 v25, s6
    v_mov_b32 v120, s6
    v_mov_b32 v121, s50
    ds_read_b128 v[74:77], v89
    ds_read_b128 v[34:37], v88
    ds_read_b32 v255, v90
    v_xor_b32 v91, 256, v88
    ds_read_b128 v[80:83], v91
    v_xor_b32 v91, 512, v88
    ds_read_b128 v[84:87], v91
    v_xor_b32 v91, 768, v88
    ds_read_b128 v[88:91], v91
    s_waitcnt lgkmcnt(0)
    v_mfma_f32_16x16x32_bf16 v[104:107], v[100:103], v[34:37], 0
    v_mfma_f32_16x16x32_bf16 v[104:107], v[100:103], v[80:83], v[104:107]
    v_mfma_f32_16x16x32_bf16 v[104:107], v[100:103], v[84:87], v[104:107]
    v_mfma_f32_16x16x32_bf16 v[104:107], v[100:103], v[88:91], v[104:107]
    v_and_b32 v30, 0xffff0000, v255
    v_lshlrev_b32 v255, 16, v255
    s_nop 5
    v_add_f32_dpp v104, v104, v104 quad_perm:[1,0,3,2] row_mask:0xf bank_mask:0xf
    s_nop 1
    v_add_f32_dpp v104, v104, v104 quad_perm:[2,3,0,1] row_mask:0xf bank_mask:0xf
    v_mul_f32 v104, 0xbb000000, v104
L_sq:
    s_mov_b64 exec, 1
    ds_read_b32 v64, v59 offset:16
    s_mov_b64 exec, -1
    s_sub_u32 s8, s8, 1
    s_cbranch_scc1 L_end
    s_waitcnt lgkmcnt(0)
    v_readfirstlane_b32 s9, v64
    s_cmp_lt_u32 s9, 2
    s_cbranch_scc1 L_sq
    ds_read_b64_tr_b16 v[128:129], v56 offset:0
    ds_read_b64_tr_b16 v[130:131], v56 offset:512
    ds_read_b64_tr_b16 v[132:133], v56 offset:1024
    ds_read_b64_tr_b16 v[134:135], v56 offset:1536
    ds_read_b64_tr_b16 v[136:137], v56 offset:2048
    ds_read_b64_tr_b16 v[138:139], v56 offset:2560
    ds_read_b64_tr_b16 v[140:141], v56 offset:3072
    ds_read_b64_tr_b16 v[142:143], v56 offset:3584
    s_waitcnt lgkmcnt(6)
    v_mfma_f32_16x16x32_bf16 v[80:83], v[128:131], v[34:37], 0
    s_waitcnt lgkmcnt(4)
    v_mfma_f32_16x16x32_bf16 v[84:87], v[132:135], v[34:37], 0
    s_waitcnt lgkmcnt(2)
    v_mfma_f32_16x16x32_bf16 v[88:91], v[136:139], v[34:37], 0
    s_waitcnt lgkmcnt(0)
    v_mfma_f32_16x16x32_bf16 v[92:95], v[140:143], v[34:37], 0
    v_mfma_f32_16x16x32_bf16 v[124:127], v[128:131], v[100:103], 0
    v_mfma_f32_16x16x32_bf16 v[124:127], v[132:135], v[100:103], v[124:127]
    v_mfma_f32_16x16x32_bf16 v[124:127], v[136:139], v[100:103], v[124:127]
    v_mfma_f32_16x16x32_bf16 v[124:127], v[140:143], v[100:103], v[124:127]
    v_add_f32_dpp v80, v84, v80 quad_perm:[1,1,1,1] row_mask:0xf bank_mask:0xf
    v_add_f32_dpp v81, v85, v81 quad_perm:[1,1,1,1] row_mask:0xf bank_mask:0xf
    v_add_f32_dpp v82, v86, v82 quad_perm:[1,1,1,1] row_mask:0xf bank_mask:0xf
    v_add_f32_dpp v83, v87, v83 quad_perm:[1,1,1,1] row_mask:0xf bank_mask:0xf
    v_add_f32_dpp v80, v88, v80 quad_perm:[2,2,2,2] row_mask:0xf bank_mask:0xf
    v_add_f32_dpp v81, v89, v81 quad_perm:[2,2,2,2] row_mask:0xf bank_mask:0xf
    v_add_f32_dpp v82, v90, v82 quad_perm:[2,2,2,2] row_mask:0xf bank_mask:0xf
    v_add_f32_dpp v83, v91, v83 quad_perm:[2,2,2,2] row_mask:0xf bank_mask:0xf
    v_add_f32_dpp v80, v92, v80 quad_perm:[3,3,3,3] row_mask:0xf bank_mask:0xf
    v_add_f32_dpp v81, v93, v81 quad_perm:[3,3,3,3] row_mask:0xf bank_mask:0xf
    v_add_f32_dpp v82, v94, v82 quad_perm:[3,3,3,3] row_mask:0xf bank_mask:0xf
    v_add_f32_dpp v83, v95, v83 quad_perm:[3,3,3,3] row_mask:0xf bank_mask:0xf
    v_fmac_f32 v80, v104, v124
    v_fmac_f32 v81, v104, v125
    v_fmac_f32 v82, v104, v126
    v_fmac_f32 v83, v104, v127
    v_bfi_b32 v80, s12, v25, v80
    v_bfi_b32 v81, s12, v25, v81
    v_bfi_b32 v82, s12, v25, v82
    v_bfi_b32 v83, s12, v25, v83
    buffer_store_dwordx4 v[80:83], v5, s[44:47], 0 offen
    buffer_store_dwordx2 v[120:121], v116, s[44:47], 0 offen
    v_bfi_b32 v124, s12, v25, v124
    v_bfi_b32 v125, s12, v25, v125
    v_bfi_b32 v126, s12, v25, v126
    v_bfi_b32 v127, s12, v25, v127
    buffer_store_dwordx4 v[124:127], v118, s[44:47], 0 offen
    buffer_store_dwordx4 v[112:115], v60, s[44:47], 0 offen
    s_add_u32 s40, s38, 0x400000
    s_addc_u32 s41, s39, 0
    s_mov_b32 s42, 0x200000
    s_mov_b32 s43, 0x20000
    s_mov_b32 s16, s34
    s_mov_b32 s17, s35
    s_movk_i32 s18, 0x1000
    s_mov_b32 s19, 0x20000
    s_and_b32 s14, s4, 7
    s_sub_u32 s52, s14, s3
    s_lshr_b32 s53, s3, 1
    s_mul_i32 s53, s53, 7
    s_and_b32 s11, s3, 1
    s_lshl_b32 s9, s11, 2
    s_add_u32 s53, s53, s9
    s_sub_u32 s11, 4, s11
    s_cmp_lt_u32 s15, s11
    s_cselect_b32 s49, 1, 0
    s_lshl_b32 s9, s3, 2
    s_add_u32 s9, s9, s15
    s_add_u32 s58, s53, s15
    s_lshr_b32 s10, s3, 1
    s_add_u32 s10, s10, 28
    s_cmp_eq_u32 s49, 0
    s_cselect_b32 s58, s10, s58
    s_cselect_b32 s11, 0, s15
    s_mul_i32 s10, s11, 5120
    s_add_u32 s10, s10, 0xe000
    s_lshl_b32 s11, s5, 10
    s_add_u32 s10, s10, s11
    v_mul_u32_u24 v85, 20480, v49
    v_and_b32 v86, 1, v50
    v_lshl_add_u32 v85, v86, 9, v85
    v_lshl_add_u32 v85, v51, 4, v85
    v_add_u32 v8, s10, v85
    s_lshl_b32 s10, s14, 2
    s_add_u32 s10, s10, s5
    v_lshlrev_b32 v84, 13, v50
    s_mov_b32 s55, 0x10001
    s_lshr_b32 s11, s6, 1
    v_add_u32 v85, s11, v48
    v_and_b32 v86, 3, v85
    v_bfe_u32 v85, v85, 2, 2
    v_mul_u32_u24 v86, 0x8001, v86
    v_mul_u32_u24 v85, 0x8001, v85
    v_bfe_i32 v87, v1, 3, 1
    v_xor_b32 v47, v86, v87
    v_xor_b32 v15, v85, v87
    v_lshrrev_b32 v85, 1, v51
    v_add_u32 v85, s11, v85
    v_and_b32 v86, 3, v85
    v_bfe_u32 v85, v85, 2, 2
    v_mul_u32_u24 v13, 0x8001, v86
    v_mul_u32_u24 v16, 0x8001, v85
    s_bfe_i32 s64, s58, 0x10000
    s_bfe_i32 s62, s9, 0x10000
    s_lshr_b32 s11, s10, 1
    s_lshl_b32 s11, s11, 15
    s_and_b32 s10, s10, 1
    s_lshl_b32 s10, s10, 12
    s_add_u32 s10, s10, s11
    v_lshl_add_u32 v85, v51, 3, v84
    v_add_u32 v85, s10, v85
    s_lshl_b32 s9, s9, 7
    v_add_u32 v252, s9, v85
    s_lshl_b32 s11, s58, 7
    v_add_u32 v14, s11, v85
    s_lshr_b32 s11, s4, 1
    s_lshl_b32 s11, s11, 15
    s_and_b32 s10, s4, 1
    s_lshl_b32 s10, s10, 12
    s_add_u32 s10, s10, s11
    v_add_u32 v253, s10, v54
    v_cmp_gt_u32 vcc, 8, v51
    s_nop 1
    v_cndmask_b32 v254, v55, v254, vcc
    v_and_b32 v85, 1, v53
    v_lshlrev_b32 v85, 4, v85
    v_mov_b32 v86, 0x3f80
    v_lshlrev_b32 v85, v85, v86
    v_and_b32 v86, 1, v52
    v_lshrrev_b32 v87, 1, v53
    v_lshl_add_u32 v86, v86, 1, v87
    v_cmp_eq_u32 vcc, 0, v86
    s_nop 1
    v_cndmask_b32 v248, 0, v85, vcc
    v_cmp_eq_u32 vcc, 1, v86
    s_nop 1
    v_cndmask_b32 v249, 0, v85, vcc
    v_cmp_eq_u32 vcc, 2, v86
    s_nop 1
    v_cndmask_b32 v250, 0, v85, vcc
    v_cmp_eq_u32 vcc, 3, v86
    s_nop 1
    v_cndmask_b32 v251, 0, v85, vcc
    v_and_b32 v86, 1, v1
    s_lshl_b32 s10, s4, 8
    s_lshl_b32 s11, s5, 6
    s_add_u32 s10, s10, s11
    s_add_u32 s10, s10, 0x18000
    v_lshlrev_b32 v84, 2, v51
    v_lshl_add_u32 v85, v50, 13, v84
    v_add_u32 v10, s10, v85
    s_lshl_b32 s10, s15, 2
    s_add_u32 s10, s10, s5
    s_lshl_b32 s9, s10, 11
    s_add_u32 s9, s9, 0x18000
    v_add_u32 v12, s9, v54
    s_lshl_b32 s10, s10, 7
    s_add_u32 s10, s10, 0x800
    v_add_u32 v85, v50, v48
    v_and_b32 v85, 7, v85
    v_lshl_add_u32 v11, v85, 4, s10
    s_lshl_b32 s10, s4, 4
    s_lshl_b32 s9, s5, 9
    s_add_u32 s10, s10, s9
    s_add_u32 s10, s10, 0x800
    v_mov_b32 v85, s10
    s_lshl_b32 s9, s5, 4
    v_cmp_eq_u32 vcc, s9, v1
    s_nop 1
    v_cndmask_b32 v9, v55, v85, vcc
    v_xor_b32 v85, v50, v51
    v_lshlrev_b32 v85, 4, v85
    v_lshl_add_u32 v85, v51, 9, v85
    s_lshl_b32 s10, s5, 13
    s_add_u32 s10, s10, 0
    v_add_u32 v44, s10, v85
    s_mul_i32 s10, s5, 288
    s_add_u32 s10, s10, 122880
    v_lshl_add_u32 v17, v1, 2, s10
    v_lshlrev_b32 v86, 4, v50
    s_movk_i32 s9, 288
    v_and_b32 v87, 1, v52
    v_mad_u32_u24 v85, v53, s9, v86
    v_lshl_add_u32 v88, v87, 7, v85
    v_add_u32 v18, 122880, v88
    v_lshl_add_u32 v88, v87, 6, v85
    v_add_u32 v88, 124160, v88
    s_add_u32 s10, s11, 124160
    v_mad_u32_u24 v85, v50, s9, v84
    v_add_u32 v19, s10, v85
    v_add_u32 v21, 125440, v86
    s_lshl_b32 s10, s5, 2
    v_add_u32 v85, s10, v21
    v_lshlrev_b32 v89, 2, v0
    v_add_u32 v89, 125568, v89
    v_cmp_eq_u32 vcc, 0, v51
    s_nop 1
    v_cndmask_b32 v20, v89, v85, vcc
    s_movk_i32 s9, 320
    v_mad_u32_u24 v85, v52, s9, v86
    v_add_u32 v22, 127488, v85
    s_mul_i32 s10, s5, 320
    s_add_u32 s10, s10, 127488
    v_lshlrev_b32 v85, 4, v51
    v_lshl_add_u32 v85, v50, 2, v85
    v_add_u32 v89, s10, v85
    s_movk_i32 s9, 192
    v_mad_u32_u24 v85, v52, s9, v86
    v_add_u32 v24, 128768, v85
    s_mul_i32 s10, s5, 192
    s_add_u32 s10, s10, 128768
    v_and_b32 v85, 1, v50
    v_lshl_add_u32 v85, v85, 1, v49
    v_lshl_add_u32 v85, v51, 2, v85
    v_lshl_add_u32 v23, v85, 1, s10
    v_lshlrev_b32 v85, 4, v87
    v_mov_b32 v86, 0xffff
    v_lshlrev_b32 v85, v85, v86
    v_mov_b32 v86, v53
    v_cmp_eq_u32 vcc, 0, v86
    s_nop 1
    v_cndmask_b32 v48, 0, v85, vcc
    v_cmp_eq_u32 vcc, 1, v86
    s_nop 1
    v_cndmask_b32 v49, 0, v85, vcc
    v_cmp_eq_u32 vcc, 2, v86
    s_nop 1
    v_cndmask_b32 v50, 0, v85, vcc
    v_cmp_eq_u32 vcc, 3, v86
    s_nop 1
    v_cndmask_b32 v51, 0, v85, vcc
    v_mul_u32_u24 v52, 0xaaaa, v87
    v_or_b32 v52, 0x4444, v52
    v_mov_b32 v53, v88
    v_mov_b32 v54, v89
    s_mov_b32 s63, 0x8000
    s_mov_b32 s65, 0x41800000
    v_mov_b32 v85, 0
    ds_write_b32 v20, v85
    ds_write_b32 v20, v85 offset:64
    buffer_load_dwordx4 v[144:147], v7, s[44:47], 0 offen sc1
    buffer_load_dwordx4 v[148:151], v7, s[44:47], 0 offen offset:2048 sc1
    buffer_load_dwordx2 v[176:177], v117, s[44:47], 0 offen sc1
    v_dot2_f32_bf16 v96, v74, s51, 0
    v_dot2_f32_bf16 v97, v74, v74, 0
    v_dot2_f32_bf16 v96, v75, s51, v96
    v_dot2_f32_bf16 v97, v75, v75, v97
    v_dot2_f32_bf16 v96, v76, s51, v96
    v_dot2_f32_bf16 v97, v76, v76, v97
    v_dot2_f32_bf16 v96, v77, s51, v96
    v_dot2_f32_bf16 v97, v77, v77, v97
    v_mov_b32 v98, 0x3b000000
    s_nop 0
    v_add_f32_dpp v96, v96, v96 quad_perm:[1,0,3,2] row_mask:0xf bank_mask:0xf
    v_add_f32_dpp v97, v97, v97 quad_perm:[1,0,3,2] row_mask:0xf bank_mask:0xf
    s_nop 0
    v_add_f32_dpp v96, v96, v96 quad_perm:[2,3,0,1] row_mask:0xf bank_mask:0xf
    v_add_f32_dpp v97, v97, v97 quad_perm:[2,3,0,1] row_mask:0xf bank_mask:0xf
    s_nop 0
    v_add_f32_dpp v96, v96, v96 row_half_mirror row_mask:0xf bank_mask:0xf
    v_add_f32_dpp v97, v97, v97 row_half_mirror row_mask:0xf bank_mask:0xf
    s_nop 0
    v_add_f32_dpp v96, v96, v96 row_mirror row_mask:0xf bank_mask:0xf
    v_add_f32_dpp v97, v97, v97 row_mirror row_mask:0xf bank_mask:0xf
    s_nop 0
    v_add_f32_dpp v96, v96, v96 row_bcast:15 row_mask:0xa bank_mask:0xf
    v_add_f32_dpp v97, v97, v97 row_bcast:15 row_mask:0xa bank_mask:0xf
    s_nop 0
    v_add_f32_dpp v96, v96, v96 row_bcast:31 row_mask:0xc bank_mask:0xf
    v_add_f32_dpp v97, v97, v97 row_bcast:31 row_mask:0xc bank_mask:0xf
    v_readlane_b32 s9, v96, 63
    v_readlane_b32 s10, v97, 63
    s_nop 0
    v_mul_f32 v96, s9, v98
    v_mul_f32 v97, s10, v98
    v_fma_f32 v97, -v96, v96, v97
    v_max_f32 v97, 0, v97
    v_add_f32 v97, 0x3727c5ac, v97
    v_rsq_f32 v33, v97
    s_nop 0
    v_mul_f32 v33, 0x3e0293ee, v33
    v_mul_f32 v78, -v96, v33
    s_sleep 8
    buffer_load_dwordx4 v[144:147], v7, s[44:47], 0 offen sc1
    buffer_load_dwordx4 v[148:151], v7, s[44:47], 0 offen offset:2048 sc1
    buffer_load_dwordx2 v[176:177], v117, s[44:47], 0 offen sc1
    s_memtime s[20:21]
    s_waitcnt lgkmcnt(0)
    s_load_dword s9, s[60:61], 0
    s_waitcnt lgkmcnt(0)
    s_memtime s[22:23]
    s_waitcnt lgkmcnt(0)
    s_load_dword s9, s[60:61], 8192
    s_waitcnt lgkmcnt(0)
    s_memtime s[10:11]
    s_waitcnt lgkmcnt(0)
    s_lshl_b32 s9, s22, 1
    s_sub_u32 s9, s9, s20
    s_sub_u32 s9, s9, s10
    s_max_i32 s9, s9, -400
    s_min_i32 s9, s9, 400
    v_mov_b32 v64, s9
    s_mov_b64 exec, 1
    ds_add_u32 v59, v64 offset:28
    s_mov_b64 exec, -1
L_sk:
    s_mov_b64 exec, 1
    ds_read_b32 v64, v59 offset:16
    s_mov_b64 exec, -1
    s_sub_u32 s8, s8, 1
    s_cbranch_scc1 L_end
    s_waitcnt lgkmcnt(0)
    v_readfirstlane_b32 s9, v64
    s_cmp_lt_u32 s9, 3
    s_cbranch_scc1 L_sk
    ds_read_b128 v[184:187], v44 offset:0
    ds_read_b128 v[200:203], v44 offset:256
    v_xor_b32 v96, 64, v44
    ds_read_b128 v[188:191], v96 offset:0
    ds_read_b128 v[204:207], v96 offset:256
    v_xor_b32 v96, 128, v44
    ds_read_b128 v[192:195], v96 offset:0
    ds_read_b128 v[208:211], v96 offset:256
    v_xor_b32 v96, 192, v44
    ds_read_b128 v[196:199], v96 offset:0
    ds_read_b128 v[212:215], v96 offset:256
    s_branch L_q1w
L_q1poll:
    s_add_u32 s13, s13, 1
    s_cmp_lg_u32 s13, 16
    s_cbranch_scc1 L_q1again
    buffer_store_dwordx2 v[120:121], v116, s[44:47], 0 offen sc1
    buffer_store_dwordx4 v[80:83], v5, s[44:47], 0 offen sc1
    buffer_store_dwordx4 v[124:127], v118, s[44:47], 0 offen sc1
L_q1again:
    buffer_load_dwordx4 v[144:147], v7, s[44:47], 0 offen sc1
    buffer_load_dwordx4 v[148:151], v7, s[44:47], 0 offen offset:2048 sc1
    buffer_load_dwordx2 v[176:177], v117, s[44:47], 0 offen sc1
    s_sub_u32 s8, s8, 1
    s_cbranch_scc1 L_end
L_q1w:
    s_waitcnt vmcnt(3)
    v_cmp_ne_u32 s[10:11], s6, v176
    v_bitop3_b32 v84, v144, v145, s6 bitop3:0x7e
    v_bitop3_b32 v85, v146, v147, s6 bitop3:0x7e
    v_bitop3_b32 v86, v148, v149, s6 bitop3:0x7e
    v_bitop3_b32 v87, v150, v151, s6 bitop3:0x7e
    v_or3_b32 v84, v84, v85, v86
    v_bitop3_b32 v87, v87, v84, s12 bitop3:0xa8
    v_cmp_ne_u32 vcc, 0, v87
    s_or_b64 vcc, vcc, s[10:11]
    s_cbranch_vccnz L_q1poll
    v_cmp_ne_u32 vcc, s50, v177
    v_mov_b32 v31, 0
    v_mov_b32 v32, 0
    s_cbranch_vccnz L_slow
    v_pk_add_f32 v[72:73], v[144:145], v[148:149]
    v_pk_add_f32 v[74:75], v[146:147], v[150:151]
    s_nop 1
    v_permlane32_swap_b32 v72, v74
    v_permlane32_swap_b32 v73, v75
    v_add_f32 v76, v72, v74
    v_add_f32 v77, v73, v75
    v_fma_f32 v76, v76, v33, v31
    v_fma_f32 v77, v77, v33, v32
    v_cvt_pk_bf16_f32 v76, v76, v77
    ds_write_b32 v17, v76
    v_mov_b64 v[80:81], 0
    v_mov_b64 v[84:85], 0
    v_mov_b64 v[88:89], 0
    v_mov_b64 v[96:97], 0
    v_mov_b64 v[100:101], 0
    v_mov_b32 v120, 0
    v_mov_b32 v112, s51
    v_mov_b32 v113, s51
    v_mov_b32 v114, s51
    v_mov_b32 v115, s51
    v_mov_b32 v116, s51
    v_mov_b32 v117, s51
    v_mov_b32 v118, s51
    v_mov_b32 v119, s51
    v_mov_b32 v122, s6
    v_mov_b32 v123, s6
    v_mov_b32 v64, 1
    s_mov_b64 exec, 1
    ds_add_u32 v59, v64 offset:20
    s_mov_b64 exec, -1
F0_sq:
    s_mov_b64 exec, 1
    ds_read_b32 v64, v59 offset:20
    s_mov_b64 exec, -1
    s_sub_u32 s8, s8, 1
    s_cbranch_scc1 L_end
    s_waitcnt lgkmcnt(0)
    v_readfirstlane_b32 s9, v64
    s_cmp_lt_u32 s9, 4
    s_cbranch_scc1 F0_sq
    ds_read_b128 v[64:67], v18 offset:0
    ds_read_b128 v[68:71], v18 offset:64
    v_xor_b32 v79, 32, v45
    ds_read_b32 v123, v59 offset:28
    s_waitcnt lgkmcnt(0)
    s_waitcnt lgkmcnt(1)
    v_smfmac_f32_16x16x64_bf16 v[80:83], v[64:67], v[184:191], v52
    v_smfmac_f32_16x16x64_bf16 v[84:87], v[64:67], v[200:207], v52
    s_waitcnt lgkmcnt(0)
    v_smfmac_f32_16x16x64_bf16 v[80:83], v[68:71], v[192:199], v52
    v_smfmac_f32_16x16x64_bf16 v[84:87], v[68:71], v[208:215], v52
    s_nop 6
    v_add_f32 v72, v80, v81
    v_add_f32 v73, v84, v85
    v_exp_f32 v74, v72
    v_exp_f32 v75, v73
    v_max_f32 v76, |v72|, |v73|
    v_cvt_pk_bf16_f32 v74, v74, v75
    v_cmp_nge_f32 vcc, s65, v76
    ds_write_b32 v19, v74
    s_cbranch_vccnz F0_mx
F0_mxr:
    v_mov_b32 v64, 1
    s_mov_b64 exec, 1
    ds_add_u32 v59, v64 offset:24
    s_mov_b64 exec, -1
F0_sp:
    s_mov_b64 exec, 1
    ds_read2_b32 v[64:65], v59 offset0:6 offset1:4
    s_mov_b64 exec, -1
    s_sub_u32 s8, s8, 1
    s_cbranch_scc1 L_end
    s_waitcnt lgkmcnt(0)
    v_readfirstlane_b32 s9, v64
    v_readfirstlane_b32 s10, v65
    s_cmp_lt_u32 s9, 4
    s_cbranch_scc1 F0_sp
    s_cmp_lt_u32 s10, 4
    s_cbranch_scc1 F0_sp
    ds_read_b128 v[64:67], v53 offset:0
    ds_read_b128 v[68:71], v53 offset:128
    ds_read_b128 v[72:75], v21 offset:0
    ds_read_b64_tr_b16 v[216:217], v45 offset:0
    ds_read_b64_tr_b16 v[218:219], v45 offset:512
    ds_read_b64_tr_b16 v[220:221], v45 offset:4096
    ds_read_b64_tr_b16 v[222:223], v45 offset:4608
    ds_read_b64_tr_b16 v[224:225], v79 offset:0
    ds_read_b64_tr_b16 v[226:227], v79 offset:512
    ds_read_b64_tr_b16 v[228:229], v79 offset:4096
    ds_read_b64_tr_b16 v[230:231], v79 offset:4608
    ds_read_b64_tr_b16 v[232:233], v45 offset:16384
    ds_read_b64_tr_b16 v[234:235], v45 offset:16896
    ds_read_b64_tr_b16 v[236:237], v45 offset:20480
    ds_read_b64_tr_b16 v[238:239], v45 offset:20992
    s_waitcnt lgkmcnt(12)
    v_smfmac_f32_16x16x64_bf16 v[88:91], v[64:67], v[112:119], v52
    v_or3_b32 v78, v72, v73, v74
    v_smfmac_f32_16x16x64_bf16 v[88:91], v[68:71], v[112:119], v52
    v_or_b32 v78, v78, v75
    s_waitcnt lgkmcnt(8)
    ds_read_b64_tr_b16 v[240:241], v79 offset:16384
    ds_read_b64_tr_b16 v[242:243], v79 offset:16896
    ds_read_b64_tr_b16 v[244:245], v79 offset:20480
    ds_read_b64_tr_b16 v[246:247], v79 offset:20992
    v_smfmac_f32_16x16x64_bf16 v[96:99], v[64:67], v[216:223], v52
    v_cmp_ne_u32 vcc, 0, v78
    s_waitcnt lgkmcnt(8)
    v_smfmac_f32_16x16x64_bf16 v[100:103], v[64:67], v[224:231], v52
    s_waitcnt lgkmcnt(4)
    v_smfmac_f32_16x16x64_bf16 v[96:99], v[68:71], v[232:239], v52
    s_waitcnt lgkmcnt(0)
    v_smfmac_f32_16x16x64_bf16 v[100:103], v[68:71], v[240:247], v52
    v_add_f32 v121, v88, v89
    s_cbranch_vccnz F0_pv
    buffer_store_dwordx4 v[120:123], v9, s[44:47], 0 offen
    s_nop 2
    v_add_f32 v76, v96, v97
    s_nop 0
    v_add_f32 v77, v100, v101
F0_pvr:
    v_cvt_pk_bf16_f32 v76, v76, v77
    v_min_u32 v76, -2, v76
    buffer_store_dword v76, v10, s[44:47], s63 offen
    v_mov_b64 v[92:93], -1
    buffer_store_dwordx2 v[92:93], v14, s[40:43], 0 offen sc1
F0_so:
    s_mov_b64 exec, 1
    ds_read_b32 v64, v59 offset:16
    s_mov_b64 exec, -1
    s_sub_u32 s8, s8, 1
    s_cbranch_scc1 L_end
    s_waitcnt lgkmcnt(0)
    v_readfirstlane_b32 s9, v64
    s_cmp_lt_u32 s9, 5
    s_cbranch_scc1 F0_so
    v_and_b32 v88, s51, v48
    v_and_b32 v89, s51, v49
    v_and_b32 v90, s51, v50
    v_and_b32 v91, s51, v51
    buffer_load_dwordx4 v[124:127], v11, s[44:47], 0 offen sc1
    buffer_load_dwordx4 v[38:41], v12, s[44:47], s63 offen sc1
    buffer_load_dwordx4 v[42:45], v12, s[44:47], s63 offen offset:1024 sc1
    s_nop 7
    s_mov_b64 vcc, -1
F0_s3poll:
    s_mov_b64 exec, vcc
    buffer_load_dwordx4 v[124:127], v11, s[44:47], 0 offen sc1
    buffer_load_dwordx4 v[38:41], v12, s[44:47], s63 offen sc1
    buffer_load_dwordx4 v[42:45], v12, s[44:47], s63 offen offset:1024 sc1
    s_mov_b64 exec, -1
    s_sub_u32 s8, s8, 1
    s_cbranch_scc1 L_end
    s_waitcnt vmcnt(5)
    v_cmp_ne_u32 s[10:11], s6, v126
    v_mov_b64 v[64:65], v[124:125]
    v_add_f32_dpp v85, v125, v125 quad_perm:[1,0,3,2] row_mask:0xf bank_mask:0xf
    v_cmp_ne_u32 s[20:21], 0, v64
    s_nop 0
    v_add_f32_dpp v85, v85, v85 quad_perm:[2,3,0,1] row_mask:0xf bank_mask:0xf
    s_waitcnt vmcnt(3)
    v_max3_u32 v86, v38, v39, v40
    v_max3_u32 v76, v41, v42, v43
    v_max_u32 v77, v44, v45
    v_mfma_f32_16x16x32_bf16 v[80:83], v[88:91], v[38:41], 0
    v_add_f32_dpp v85, v85, v85 row_half_mirror row_mask:0xf bank_mask:0xf
    v_mfma_f32_16x16x32_bf16 v[80:83], v[88:91], v[42:45], v[80:83]
    v_max3_u32 v86, v86, v76, v77
    v_rcp_f32 v85, v85
    v_cmp_ne_u64 vcc, v[64:65], v[124:125]
    v_cmp_eq_u32 s[22:23], -1, v86
    s_or_b64 vcc, vcc, s[10:11]
    s_nop 2
    v_mul_f32 v80, v80, v85
    v_mul_f32 v81, v81, v85
    s_or_b64 vcc, vcc, s[22:23]
    v_cvt_pk_bf16_f32 v80, v80, v81
    s_cmp_lg_u64 s[20:21], 0
    ds_write_b32 v54, v80
    s_cbranch_vccnz F0_s3poll
    s_cbranch_scc1 F0_wg
F0_wgr:
    s_waitcnt lgkmcnt(0)
    s_barrier
    ds_read_b128 v[64:67], v22 offset:0
    ds_read_b64_tr_b16 v[160:161], v57 offset:0
    ds_read_b64_tr_b16 v[162:163], v57 offset:256
    ds_read_b128 v[68:71], v22 offset:64
    ds_read_b64_tr_b16 v[164:165], v57 offset:1024
    ds_read_b64_tr_b16 v[166:167], v57 offset:1280
    ds_read_b128 v[72:75], v22 offset:128
    ds_read_b64_tr_b16 v[168:169], v57 offset:2048
    ds_read_b64_tr_b16 v[170:171], v57 offset:2304
    ds_read_b128 v[76:79], v22 offset:192
    ds_read_b64_tr_b16 v[172:173], v57 offset:3072
    ds_read_b64_tr_b16 v[174:175], v57 offset:3328
    s_mov_b32 s56, 0x180000
    v_xor_b32 v86, s62, v13
    v_xor_b32 v87, s62, v16
    s_waitcnt lgkmcnt(9)
    v_mfma_f32_16x16x32_bf16 v[80:83], v[64:67], v[160:163], 0
    s_waitcnt lgkmcnt(6)
    v_mfma_f32_16x16x32_bf16 v[80:83], v[68:71], v[164:167], v[80:83]
    s_waitcnt lgkmcnt(3)
    v_mfma_f32_16x16x32_bf16 v[80:83], v[72:75], v[168:171], v[80:83]
    s_waitcnt lgkmcnt(0)
    v_mfma_f32_16x16x32_bf16 v[80:83], v[76:79], v[172:175], v[80:83]
    s_nop 7
    v_cvt_pk_bf16_f32 v84, v80, v81
    v_cvt_pk_bf16_f32 v85, v82, v83
    v_bfi_b32 v84, s55, v86, v84
    v_bfi_b32 v85, s55, v87, v85
    buffer_store_dwordx2 v[84:85], v252, s[40:43], s56 offen sc1
    v_mov_b64 v[92:93], -1
    s_mov_b32 s9, 0x80000
    s_mov_b32 s10, 0x100000
    buffer_store_dwordx2 v[92:93], v252, s[40:43], s9 offen sc1
    buffer_store_dwordx2 v[92:93], v14, s[40:43], s10 offen sc1
    v_add_u32_dpp v88, v127, v127 quad_perm:[1,0,3,2] row_mask:0xf bank_mask:0xf
    s_nop 1
    v_add_u32_dpp v88, v88, v88 quad_perm:[2,3,0,1] row_mask:0xf bank_mask:0xf
    s_nop 1
    v_add_u32_dpp v88, v88, v88 row_half_mirror row_mask:0xf bank_mask:0xf
    s_nop 0
    v_readfirstlane_b32 s9, v88
    s_cmp_gt_i32 s9, 0
    s_cselect_b32 s11, 0x2000, 0
    v_add_u32 v253, s11, v253
    ds_read_b32 v64, v59 offset:16
    s_waitcnt lgkmcnt(0)
    v_readfirstlane_b32 s48, v64
    s_cmp_lt_u32 s48, 6
    s_cbranch_scc1 F0_n13
    ds_read_b64_tr_b16 v[144:145], v56 offset:32768
    ds_read_b64_tr_b16 v[146:147], v56 offset:33280
    ds_read_b64_tr_b16 v[148:149], v56 offset:33792
    ds_read_b64_tr_b16 v[150:151], v56 offset:34304
    ds_read_b64_tr_b16 v[152:153], v56 offset:34816
    ds_read_b64_tr_b16 v[154:155], v56 offset:35328
    ds_read_b64_tr_b16 v[156:157], v56 offset:35840
    ds_read_b64_tr_b16 v[158:159], v56 offset:36352
    v_mov_b32 v100, s51
    v_mov_b32 v101, s51
    v_mov_b32 v102, s51
    v_mov_b32 v103, s51
    s_waitcnt lgkmcnt(0)
    s_nop 0
    v_mfma_f32_16x16x32_bf16 v[96:99], v[144:147], v[100:103], 0
    v_mfma_f32_16x16x32_bf16 v[96:99], v[148:151], v[100:103], v[96:99]
    v_mfma_f32_16x16x32_bf16 v[96:99], v[152:155], v[100:103], v[96:99]
    v_mfma_f32_16x16x32_bf16 v[96:99], v[156:159], v[100:103], v[96:99]
    s_nop 7
    v_bfi_b32 v96, s12, v25, v96
    v_bfi_b32 v97, s12, v25, v97
    v_bfi_b32 v98, s12, v25, v98
    v_bfi_b32 v99, s12, v25, v99
    buffer_store_dwordx4 v[96:99], v46, s[44:47], 0 offen
F0_n13:
    s_mov_b32 s58, 0xb000
    s_cmp_lg_u32 s5, 0
    s_cbranch_scc1 F0_s4_oth
    s_and_b32 s56, s50, 1
    s_lshl_b32 s56, s56, 14
    s_add_u32 s56, s56, 0x180000
    s_sleep 8
    s_xor_b32 s11, s56, 0x4000
    buffer_load_dwordx4 v[64:67], v253, s[40:43], s56 offen offset:0 sc1
    buffer_load_dwordx4 v[68:71], v253, s[40:43], s56 offen offset:1024 sc1
    buffer_load_dwordx4 v[72:75], v253, s[40:43], s56 offen offset:2048 sc1
    buffer_load_dwordx4 v[76:79], v253, s[40:43], s56 offen offset:3072 sc1
    s_sleep 4
    buffer_load_dwordx4 v[112:115], v253, s[40:43], s11 offen offset:0 sc1
    buffer_load_dwordx4 v[116:119], v253, s[40:43], s11 offen offset:1024 sc1
    buffer_load_dwordx4 v[120:123], v253, s[40:43], s11 offen offset:2048 sc1
    buffer_load_dwordx4 v[124:127], v253, s[40:43], s11 offen offset:3072 sc1
    s_waitcnt vmcnt(7)
    v_mfma_f32_16x16x32_bf16 v[80:83], v[248:251], v[64:67], 0
    v_bitop3_b32 v84, v64, v66, v47 bitop3:0x7e
    v_bitop3_b32 v85, v65, v67, v15 bitop3:0x7e
    s_waitcnt vmcnt(6)
    v_mfma_f32_16x16x32_bf16 v[80:83], v[248:251], v[68:71], v[80:83]
    v_bitop3_b32 v86, v68, v70, v47 bitop3:0x7e
    v_bitop3_b32 v87, v69, v71, v15 bitop3:0x7e
    v_or3_b32 v84, v84, v85, v86
    s_waitcnt vmcnt(5)
    v_mfma_f32_16x16x32_bf16 v[80:83], v[248:251], v[72:75], v[80:83]
    v_bitop3_b32 v88, v72, v74, v47 bitop3:0x7e
    v_bitop3_b32 v89, v73, v75, v15 bitop3:0x7e
    v_or3_b32 v84, v84, v87, v88
    s_waitcnt vmcnt(4)
    v_mfma_f32_16x16x32_bf16 v[80:83], v[248:251], v[76:79], v[80:83]
    v_bitop3_b32 v90, v76, v78, v47 bitop3:0x7e
    v_bitop3_b32 v91, v77, v79, v15 bitop3:0x7e
    v_or3_b32 v89, v89, v90, v91
    v_bitop3_b32 v84, v84, v89, s55 bitop3:0xa8
    v_cmp_ne_u32 vcc, 0, v84
    s_nop 2
    v_add_f32_dpp v80, v80, v80 row_ror:8 row_mask:0xf bank_mask:0xf
    v_add_f32_dpp v81, v81, v81 row_ror:8 row_mask:0xf bank_mask:0xf
    s_cbranch_vccnz F0_s4_b
F0_s4_ok:
    v_cvt_pk_bf16_f32 v80, v80, v81
    v_and_b32 v81, 0xffff0000, v80
    v_lshlrev_b32 v80, 16, v80
    v_add_f32 v81, v81, v30
    v_add_f32 v80, v80, v255
    v_cvt_pk_bf16_f32 v80, v80, v81
    v_min_u32 v81, -2, v80
    buffer_store_dword v81, v254, s[44:47], s58 offen
    v_lshlrev_b32 v255, 16, v80
    v_and_b32 v30, 0xffff0000, v80
    s_branch F0_s4_oth
F0_s4_b:
    buffer_load_dwordx4 v[64:67], v253, s[40:43], s56 offen offset:0 sc1
    buffer_load_dwordx4 v[68:71], v253, s[40:43], s56 offen offset:1024 sc1
    buffer_load_dwordx4 v[72:75], v253, s[40:43], s56 offen offset:2048 sc1
    buffer_load_dwordx4 v[76:79], v253, s[40:43], s56 offen offset:3072 sc1
    s_waitcnt vmcnt(7)
    v_mfma_f32_16x16x32_bf16 v[80:83], v[248:251], v[112:115], 0
    v_bitop3_b32 v84, v112, v114, v47 bitop3:0x7e
    v_bitop3_b32 v85, v113, v115, v15 bitop3:0x7e
    s_waitcnt vmcnt(6)
    v_mfma_f32_16x16x32_bf16 v[80:83], v[248:251], v[116:119], v[80:83]
    v_bitop3_b32 v86, v116, v118, v47 bitop3:0x7e
    v_bitop3_b32 v87, v117, v119, v15 bitop3:0x7e
    v_or3_b32 v84, v84, v85, v86
    s_waitcnt vmcnt(5)
    v_mfma_f32_16x16x32_bf16 v[80:83], v[248:251], v[120:123], v[80:83]
    v_bitop3_b32 v88, v120, v122, v47 bitop3:0x7e
    v_bitop3_b32 v89, v121, v123, v15 bitop3:0x7e
    v_or3_b32 v84, v84, v87, v88
    s_waitcnt vmcnt(4)
    v_mfma_f32_16x16x32_bf16 v[80:83], v[248:251], v[124:127], v[80:83]
    v_bitop3_b32 v90, v124, v126, v47 bitop3:0x7e
    v_bitop3_b32 v91, v125, v127, v15 bitop3:0x7e
    v_or3_b32 v89, v89, v90, v91
    v_bitop3_b32 v84, v84, v89, s55 bitop3:0xa8
    v_cmp_ne_u32 vcc, 0, v84
    s_nop 2
    v_add_f32_dpp v80, v80, v80 row_ror:8 row_mask:0xf bank_mask:0xf
    v_add_f32_dpp v81, v81, v81 row_ror:8 row_mask:0xf bank_mask:0xf
    s_cbranch_vccz F0_s4_ok
    buffer_load_dwordx4 v[112:115], v253, s[40:43], s11 offen offset:0 sc1
    buffer_load_dwordx4 v[116:119], v253, s[40:43], s11 offen offset:1024 sc1
    buffer_load_dwordx4 v[120:123], v253, s[40:43], s11 offen offset:2048 sc1
    buffer_load_dwordx4 v[124:127], v253, s[40:43], s11 offen offset:3072 sc1
    s_sub_u32 s8, s8, 1
    s_cbranch_scc1 L_end
    s_waitcnt vmcnt(7)
    v_mfma_f32_16x16x32_bf16 v[80:83], v[248:251], v[64:67], 0
    v_bitop3_b32 v84, v64, v66, v47 bitop3:0x7e
    v_bitop3_b32 v85, v65, v67, v15 bitop3:0x7e
    s_waitcnt vmcnt(6)
    v_mfma_f32_16x16x32_bf16 v[80:83], v[248:251], v[68:71], v[80:83]
    v_bitop3_b32 v86, v68, v70, v47 bitop3:0x7e
    v_bitop3_b32 v87, v69, v71, v15 bitop3:0x7e
    v_or3_b32 v84, v84, v85, v86
    s_waitcnt vmcnt(5)
    v_mfma_f32_16x16x32_bf16 v[80:83], v[248:251], v[72:75], v[80:83]
    v_bitop3_b32 v88, v72, v74, v47 bitop3:0x7e
    v_bitop3_b32 v89, v73, v75, v15 bitop3:0x7e
    v_or3_b32 v84, v84, v87, v88
    s_waitcnt vmcnt(4)
    v_mfma_f32_16x16x32_bf16 v[80:83], v[248:251], v[76:79], v[80:83]
    v_bitop3_b32 v90, v76, v78, v47 bitop3:0x7e
    v_bitop3_b32 v91, v77, v79, v15 bitop3:0x7e
    v_or3_b32 v89, v89, v90, v91
    v_bitop3_b32 v84, v84, v89, s55 bitop3:0xa8
    v_cmp_ne_u32 vcc, 0, v84
    s_nop 2
    v_add_f32_dpp v80, v80, v80 row_ror:8 row_mask:0xf bank_mask:0xf
    v_add_f32_dpp v81, v81, v81 row_ror:8 row_mask:0xf bank_mask:0xf
    s_cbranch_vccnz F0_s4_b
    s_branch F0_s4_ok
F0_s4_oth:
    s_cmp_lt_u32 s48, 6
    s_cbranch_scc1 F0_l13
F0_l13r:
    s_nop 15
    s_barrier
    ds_read_b64_tr_b16 v[176:177], v58 offset:0
    ds_read_b64_tr_b16 v[178:179], v58 offset:512
    ds_read_b64_tr_b16 v[180:181], v58 offset:1024
    ds_read_b64_tr_b16 v[182:183], v58 offset:1536
    s_sub_u32 s56, 4, s5
    s_lshl_b32 s56, s56, 10
    buffer_load_dwordx4 v[34:37], v2, s[44:47], s58 offen sc1
    s_nop 15
    buffer_load_dwordx4 v[34:37], v2, s[44:47], s58 offen sc1
    s_nop 15
F0_s5:
    buffer_load_dwordx4 v[34:37], v2, s[44:47], s58 offen sc1
    s_sub_u32 s8, s8, 1
    s_cbranch_scc1 L_end
    s_waitcnt vmcnt(2)
    v_max3_u32 v72, v34, v35, v36
    v_max_u32 v72, v72, v37
    v_mfma_f32_16x16x32_bf16 v[80:83], v[144:147], v[34:37], 0
    v_cmp_eq_u32 vcc, -1, v72
    v_mfma_f32_16x16x32_bf16 v[84:87], v[148:151], v[34:37], 0
    v_mfma_f32_16x16x32_bf16 v[88:91], v[152:155], v[34:37], 0
    s_cbranch_vccnz F0_s5
    v_mfma_f32_16x16x32_bf16 v[92:95], v[156:159], v[34:37], 0
    buffer_load_dwordx4 v[74:77], v4, s[44:47], s58 offen sc1
    buffer_load_dwordx4 v[104:107], v8, s[44:47], s56 offen sc1
    buffer_load_dwordx4 v[108:111], v8, s[44:47], s56 offen offset:256 sc1
    s_nop 1
    v_add_f32_dpp v80, v84, v80 quad_perm:[1,1,1,1] row_mask:0xf bank_mask:0xf
    v_add_f32_dpp v81, v85, v81 quad_perm:[1,1,1,1] row_mask:0xf bank_mask:0xf
    v_add_f32_dpp v82, v86, v82 quad_perm:[1,1,1,1] row_mask:0xf bank_mask:0xf
    v_add_f32_dpp v83, v87, v83 quad_perm:[1,1,1,1] row_mask:0xf bank_mask:0xf
    v_add_f32_dpp v80, v88, v80 quad_perm:[2,2,2,2] row_mask:0xf bank_mask:0xf
    v_add_f32_dpp v81, v89, v81 quad_perm:[2,2,2,2] row_mask:0xf bank_mask:0xf
    v_add_f32_dpp v82, v90, v82 quad_perm:[2,2,2,2] row_mask:0xf bank_mask:0xf
    v_add_f32_dpp v83, v91, v83 quad_perm:[2,2,2,2] row_mask:0xf bank_mask:0xf
    v_add_f32_dpp v80, v92, v80 quad_perm:[3,3,3,3] row_mask:0xf bank_mask:0xf
    v_add_f32_dpp v81, v93, v81 quad_perm:[3,3,3,3] row_mask:0xf bank_mask:0xf
    v_add_f32_dpp v82, v94, v82 quad_perm:[3,3,3,3] row_mask:0xf bank_mask:0xf
    v_add_f32_dpp v83, v95, v83 quad_perm:[3,3,3,3] row_mask:0xf bank_mask:0xf
    v_bfi_b32 v80, s12, v25, v80
    v_bfi_b32 v81, s12, v25, v81
    v_bfi_b32 v82, s12, v25, v82
    v_bfi_b32 v83, s12, v25, v83
    buffer_store_dwordx4 v[80:83], v6, s[44:47], 0 offen
    s_waitcnt vmcnt(1)
    s_branch F0_s6st_c
F0_s6st:
    buffer_load_dwordx4 v[74:77], v4, s[44:47], s58 offen sc1
    buffer_load_dwordx4 v[104:107], v8, s[44:47], s56 offen sc1
    buffer_load_dwordx4 v[108:111], v8, s[44:47], s56 offen offset:256 sc1
    s_sub_u32 s8, s8, 1
    s_cbranch_scc1 L_end
    s_waitcnt vmcnt(0)
F0_s6st_c:
    v_max3_u32 v96, v74, v75, v76
    v_max_u32 v96, v96, v77
    v_cmp_eq_u32 vcc, -1, v96
    s_cbranch_vccnz F0_s6st
    v_bitop3_b32 v120, v104, v105, s6 bitop3:0x7e
    v_bitop3_b32 v121, v106, v107, s6 bitop3:0x7e
    v_bitop3_b32 v122, v108, v109, s6 bitop3:0x7e
    v_bitop3_b32 v123, v110, v111, s6 bitop3:0x7e
    v_or3_b32 v120, v120, v121, v122
    v_bitop3_b32 v123, v123, v120, s12 bitop3:0xa8
    v_cmp_ne_u32 vcc, 0, v123
    s_cbranch_vccnz F0_s6st
    s_cmp_lg_u32 s49, 0
    s_cbranch_scc1 F0_w2ok
    s_waitcnt lgkmcnt(0)
    v_mov_b32 v176, 0
    v_mov_b32 v177, 0
    v_mov_b32 v178, 0
    v_mov_b32 v179, 0
    v_mov_b32 v180, 0
    v_mov_b32 v181, 0
    v_mov_b32 v182, 0
    v_mov_b32 v183, 0
F0_w2ok:
    buffer_load_dwordx4 v[38:41], v8, s[44:47], 0 offen sc1
    buffer_load_dwordx4 v[42:45], v8, s[44:47], 0 offen offset:256 sc1
    v_pk_add_f32 v[104:105], v[104:105], v[108:109]
    v_pk_add_f32 v[106:107], v[106:107], v[110:111]
    s_nop 1
    v_permlane16_swap_b32 v104, v106
    v_permlane16_swap_b32 v105, v107
    v_add_f32 v28, v104, v106
    v_add_f32 v29, v105, v107
    s_nop 1
    v_permlane32_swap_b32 v28, v29
    v_dot2_f32_bf16 v96, v74, s51, 0
    v_dot2_f32_bf16 v97, v74, v74, 0
    v_dot2_f32_bf16 v96, v75, s51, v96
    v_dot2_f32_bf16 v97, v75, v75, v97
    v_dot2_f32_bf16 v96, v76, s51, v96
    v_dot2_f32_bf16 v97, v76, v76, v97
    v_dot2_f32_bf16 v96, v77, s51, v96
    v_dot2_f32_bf16 v97, v77, v77, v97
    v_mov_b32 v98, 0x3b000000
    s_nop 0
    v_add_f32_dpp v96, v96, v96 quad_perm:[1,0,3,2] row_mask:0xf bank_mask:0xf
    v_add_f32_dpp v97, v97, v97 quad_perm:[1,0,3,2] row_mask:0xf bank_mask:0xf
    s_nop 0
    v_add_f32_dpp v96, v96, v96 quad_perm:[2,3,0,1] row_mask:0xf bank_mask:0xf
    v_add_f32_dpp v97, v97, v97 quad_perm:[2,3,0,1] row_mask:0xf bank_mask:0xf
    s_nop 0
    v_add_f32_dpp v96, v96, v96 row_half_mirror row_mask:0xf bank_mask:0xf
    v_add_f32_dpp v97, v97, v97 row_half_mirror row_mask:0xf bank_mask:0xf
    s_nop 0
    v_add_f32_dpp v96, v96, v96 row_mirror row_mask:0xf bank_mask:0xf
    v_add_f32_dpp v97, v97, v97 row_mirror row_mask:0xf bank_mask:0xf
    s_nop 0
    v_add_f32_dpp v96, v96, v96 row_bcast:15 row_mask:0xa bank_mask:0xf
    v_add_f32_dpp v97, v97, v97 row_bcast:15 row_mask:0xa bank_mask:0xf
    s_nop 0
    v_add_f32_dpp v96, v96, v96 row_bcast:31 row_mask:0xc bank_mask:0xf
    v_add_f32_dpp v97, v97, v97 row_bcast:31 row_mask:0xc bank_mask:0xf
    v_readlane_b32 s9, v96, 63
    v_readlane_b32 s10, v97, 63
    s_nop 0
    v_mul_f32 v96, s9, v98
    v_mul_f32 v97, s10, v98
    v_fma_f32 v97, -v96, v96, v97
    v_max_f32 v97, 0, v97
    v_add_f32 v97, 0x3727c5ac, v97
    v_rsq_f32 v33, v97
    s_nop 0
    v_mul_f32 v78, -v96, v33
    v_mul_f32 v31, v78, v28
    v_mul_f32 v32, v78, v29
    v_mul_f32 v94, 0xbfb8aa3b, v33
    v_mul_f32 v95, 0xbfb8aa3b, v31
    s_mov_b32 s56, 0x0
    s_mov_b64 vcc, -1
F0_s6poll:
    s_mov_b64 exec, vcc
    buffer_load_dwordx4 v[38:41], v8, s[44:47], 0 offen sc1
    buffer_load_dwordx4 v[42:45], v8, s[44:47], 0 offen offset:256 sc1
    s_mov_b64 exec, -1
    s_sub_u32 s8, s8, 1
    s_cbranch_scc1 L_end
    s_waitcnt vmcnt(2)
    v_bitop3_b32 v80, v38, v39, s6 bitop3:0x7e
    v_bitop3_b32 v81, v40, v41, s6 bitop3:0x7e
    v_bitop3_b32 v82, v42, v43, s6 bitop3:0x7e
    v_bitop3_b32 v83, v44, v45, s6 bitop3:0x7e
    v_pk_add_f32 v[72:73], v[38:39], v[42:43]
    v_pk_add_f32 v[74:75], v[40:41], v[44:45]
    v_or3_b32 v80, v80, v81, v82
    v_bitop3_b32 v80, v80, v83, s12 bitop3:0xa8
    v_permlane16_swap_b32 v72, v74
    v_permlane16_swap_b32 v73, v75
    v_cmp_ne_u32 vcc, 0, v80
    v_add_f32 v72, v72, v74
    v_add_f32 v74, v73, v75
    s_nop 1
    v_permlane32_swap_b32 v72, v74
    v_fma_f32 v73, v72, v94, v95
    s_cbranch_vccnz F0_s6poll
    v_exp_f32 v73, v73
    v_fma_f32 v72, v72, v33, v31
    v_add_f32 v73, 1.0, v73
    v_fma_f32 v74, v74, v33, v32
    v_rcp_f32 v73, v73
    v_mul_f32 v74, v74, v72
    v_mul_f32 v72, v74, v73
    v_cvt_pk_bf16_f32 v72, v72, v72
    ds_write_b16 v23, v72
    s_waitcnt lgkmcnt(0)
    s_barrier
    ds_read_b128 v[64:67], v24 offset:0
    ds_read_b128 v[68:71], v24 offset:64
    s_waitcnt lgkmcnt(1)
    v_mfma_f32_16x16x32_bf16 v[80:83], v[64:67], v[176:179], 0
    s_waitcnt lgkmcnt(0)
    v_mfma_f32_16x16x32_bf16 v[80:83], v[68:71], v[180:183], v[80:83]
    s_nop 7
    v_cvt_pk_bf16_f32 v84, v80, v81
    v_cvt_pk_bf16_f32 v85, v82, v83
    v_min_u32 v84, -2, v84
    v_min_u32 v85, -2, v85
    buffer_store_dwordx2 v[84:85], v14, s[40:43], s56 offen sc1
    s_sub_u32 s57, 4, s15
    s_lshl_b32 s57, s57, 13
    buffer_load_dwordx4 v[104:107], v7, s[44:47], s57 offen sc1
    buffer_load_dwordx4 v[108:111], v7, s[44:47], s57 offen offset:2048 sc1
    s_mov_b32 s58, 0xc000
    s_cmp_lg_u32 s5, 0
    s_cbranch_scc1 F0_s7_oth
    s_and_b32 s56, s50, 1
    s_lshl_b32 s56, s56, 14
    s_add_u32 s56, s56, 0x0
    s_sleep 8
    s_xor_b32 s11, s56, 0x4000
    buffer_load_dwordx4 v[64:67], v253, s[40:43], s56 offen offset:0 sc1
    buffer_load_dwordx4 v[68:71], v253, s[40:43], s56 offen offset:1024 sc1
    buffer_load_dwordx4 v[72:75], v253, s[40:43], s56 offen offset:2048 sc1
    buffer_load_dwordx4 v[76:79], v253, s[40:43], s56 offen offset:3072 sc1
    s_sleep 4
    buffer_load_dwordx4 v[112:115], v253, s[40:43], s11 offen offset:0 sc1
    buffer_load_dwordx4 v[116:119], v253, s[40:43], s11 offen offset:1024 sc1
    buffer_load_dwordx4 v[120:123], v253, s[40:43], s11 offen offset:2048 sc1
    buffer_load_dwordx4 v[124:127], v253, s[40:43], s11 offen offset:3072 sc1
    s_waitcnt vmcnt(7)
    v_mfma_f32_16x16x32_bf16 v[80:83], v[248:251], v[64:67], 0
    v_max3_u32 v84, v64, v65, v66
    v_mov_b32 v85, v67
    s_waitcnt vmcnt(6)
    v_mfma_f32_16x16x32_bf16 v[80:83], v[248:251], v[68:71], v[80:83]
    v_max3_u32 v84, v84, v68, v69
    v_max3_u32 v85, v85, v70, v71
    s_waitcnt vmcnt(5)
    v_mfma_f32_16x16x32_bf16 v[80:83], v[248:251], v[72:75], v[80:83]
    v_max3_u32 v84, v84, v72, v73
    v_max3_u32 v85, v85, v74, v75
    s_waitcnt vmcnt(4)
    v_mfma_f32_16x16x32_bf16 v[80:83], v[248:251], v[76:79], v[80:83]
    v_max3_u32 v84, v84, v76, v77
    v_max3_u32 v85, v85, v78, v79
    v_max_u32 v84, v84, v85
    v_cmp_eq_u32 vcc, -1, v84
    s_nop 3
    v_add_f32_dpp v80, v80, v80 row_ror:8 row_mask:0xf bank_mask:0xf
    v_add_f32_dpp v81, v81, v81 row_ror:8 row_mask:0xf bank_mask:0xf
    s_cbranch_vccnz F0_s7_b
F0_s7_ok:
    v_cvt_pk_bf16_f32 v80, v80, v81
    v_and_b32 v81, 0xffff0000, v80
    v_lshlrev_b32 v80, 16, v80
    v_add_f32 v81, v81, v30
    v_add_f32 v80, v80, v255
    v_cvt_pk_bf16_f32 v80, v80, v81
    v_min_u32 v81, -2, v80
    buffer_store_dword v81, v254, s[44:47], s58 offen
    v_lshlrev_b32 v255, 16, v80
    v_and_b32 v30, 0xffff0000, v80
    s_branch F0_s7_oth
F0_s7_b:
    buffer_load_dwordx4 v[64:67], v253, s[40:43], s56 offen offset:0 sc1
    buffer_load_dwordx4 v[68:71], v253, s[40:43], s56 offen offset:1024 sc1
    buffer_load_dwordx4 v[72:75], v253, s[40:43], s56 offen offset:2048 sc1
    buffer_load_dwordx4 v[76:79], v253, s[40:43], s56 offen offset:3072 sc1
    s_waitcnt vmcnt(7)
    v_mfma_f32_16x16x32_bf16 v[80:83], v[248:251], v[112:115], 0
    v_max3_u32 v84, v112, v113, v114
    v_mov_b32 v85, v115
    s_waitcnt vmcnt(6)
    v_mfma_f32_16x16x32_bf16 v[80:83], v[248:251], v[116:119], v[80:83]
    v_max3_u32 v84, v84, v116, v117
    v_max3_u32 v85, v85, v118, v119
    s_waitcnt vmcnt(5)
    v_mfma_f32_16x16x32_bf16 v[80:83], v[248:251], v[120:123], v[80:83]
    v_max3_u32 v84, v84, v120, v121
    v_max3_u32 v85, v85, v122, v123
    s_waitcnt vmcnt(4)
    v_mfma_f32_16x16x32_bf16 v[80:83], v[248:251], v[124:127], v[80:83]
    v_max3_u32 v84, v84, v124, v125
    v_max3_u32 v85, v85, v126, v127
    v_max_u32 v84, v84, v85
    v_cmp_eq_u32 vcc, -1, v84
    s_nop 3
    v_add_f32_dpp v80, v80, v80 row_ror:8 row_mask:0xf bank_mask:0xf
    v_add_f32_dpp v81, v81, v81 row_ror:8 row_mask:0xf bank_mask:0xf
    s_cbranch_vccz F0_s7_ok
    buffer_load_dwordx4 v[112:115], v253, s[40:43], s11 offen offset:0 sc1
    buffer_load_dwordx4 v[116:119], v253, s[40:43], s11 offen offset:1024 sc1
    buffer_load_dwordx4 v[120:123], v253, s[40:43], s11 offen offset:2048 sc1
    buffer_load_dwordx4 v[124:127], v253, s[40:43], s11 offen offset:3072 sc1
    s_sub_u32 s8, s8, 1
    s_cbranch_scc1 L_end
    s_waitcnt vmcnt(7)
    v_mfma_f32_16x16x32_bf16 v[80:83], v[248:251], v[64:67], 0
    v_max3_u32 v84, v64, v65, v66
    v_mov_b32 v85, v67
    s_waitcnt vmcnt(6)
    v_mfma_f32_16x16x32_bf16 v[80:83], v[248:251], v[68:71], v[80:83]
    v_max3_u32 v84, v84, v68, v69
    v_max3_u32 v85, v85, v70, v71
    s_waitcnt vmcnt(5)
    v_mfma_f32_16x16x32_bf16 v[80:83], v[248:251], v[72:75], v[80:83]
    v_max3_u32 v84, v84, v72, v73
    v_max3_u32 v85, v85, v74, v75
    s_waitcnt vmcnt(4)
    v_mfma_f32_16x16x32_bf16 v[80:83], v[248:251], v[76:79], v[80:83]
    v_max3_u32 v84, v84, v76, v77
    v_max3_u32 v85, v85, v78, v79
    v_max_u32 v84, v84, v85
    v_cmp_eq_u32 vcc, -1, v84
    s_nop 3
    v_add_f32_dpp v80, v80, v80 row_ror:8 row_mask:0xf bank_mask:0xf
    v_add_f32_dpp v81, v81, v81 row_ror:8 row_mask:0xf bank_mask:0xf
    s_cbranch_vccnz F0_s7_b
    s_branch F0_s7_ok
F0_s7_oth:
    s_cmp_eq_u32 s5, 0
    s_cbranch_scc1 F0_qcc
F0_qcw:
    s_waitcnt vmcnt(0)
F0_qcc:
    v_bitop3_b32 v92, v104, v105, s6 bitop3:0x7e
    v_bitop3_b32 v93, v106, v107, s6 bitop3:0x7e
    v_bitop3_b32 v94, v108, v109, s6 bitop3:0x7e
    v_bitop3_b32 v95, v110, v111, s6 bitop3:0x7e
    v_or3_b32 v92, v92, v93, v94
    v_bitop3_b32 v95, v95, v92, s12 bitop3:0xa8
    v_cmp_ne_u32 vcc, 0, v95
    v_pk_add_f32 v[96:97], v[104:105], v[108:109]
    v_pk_add_f32 v[98:99], v[106:107], v[110:111]
    s_nop 1
    v_permlane32_swap_b32 v96, v98
    v_permlane32_swap_b32 v97, v99
    v_add_f32 v26, v96, v98
    v_add_f32 v27, v97, v99
    s_cbranch_vccnz F0_qcr
    s_add_u32 s6, s6, 1
    v_mov_b32 v25, s6
    s_barrier
    buffer_load_dwordx4 v[34:37], v2, s[44:47], s58 offen sc1
    s_nop 15
    buffer_load_dwordx4 v[34:37], v2, s[44:47], s58 offen sc1
    s_nop 15
F1_s1:
    buffer_load_dwordx4 v[34:37], v2, s[44:47], s58 offen sc1
    s_sub_u32 s8, s8, 1
    s_cbranch_scc1 L_end
    s_waitcnt vmcnt(2)
    v_max3_u32 v72, v34, v35, v36
    v_max_u32 v72, v72, v37
    v_mfma_f32_16x16x32_bf16 v[80:83], v[128:131], v[34:37], 0
    v_cmp_eq_u32 vcc, -1, v72
    v_mfma_f32_16x16x32_bf16 v[84:87], v[132:135], v[34:37], 0
    v_mfma_f32_16x16x32_bf16 v[88:91], v[136:139], v[34:37], 0
    s_cbranch_vccnz F1_s1
    v_mfma_f32_16x16x32_bf16 v[92:95], v[140:143], v[34:37], 0
    buffer_load_dwordx4 v[74:77], v3, s[44:47], s58 offen sc1
    s_nop 3
    v_add_f32_dpp v80, v84, v80 quad_perm:[1,1,1,1] row_mask:0xf bank_mask:0xf
    v_add_f32_dpp v81, v85, v81 quad_perm:[1,1,1,1] row_mask:0xf bank_mask:0xf
    v_add_f32_dpp v82, v86, v82 quad_perm:[1,1,1,1] row_mask:0xf bank_mask:0xf
    v_add_f32_dpp v83, v87, v83 quad_perm:[1,1,1,1] row_mask:0xf bank_mask:0xf
    v_add_f32_dpp v80, v88, v80 quad_perm:[2,2,2,2] row_mask:0xf bank_mask:0xf
    v_add_f32_dpp v81, v89, v81 quad_perm:[2,2,2,2] row_mask:0xf bank_mask:0xf
    v_add_f32_dpp v82, v90, v82 quad_perm:[2,2,2,2] row_mask:0xf bank_mask:0xf
    v_add_f32_dpp v83, v91, v83 quad_perm:[2,2,2,2] row_mask:0xf bank_mask:0xf
    v_add_f32_dpp v80, v92, v80 quad_perm:[3,3,3,3] row_mask:0xf bank_mask:0xf
    v_add_f32_dpp v81, v93, v81 quad_perm:[3,3,3,3] row_mask:0xf bank_mask:0xf
    v_add_f32_dpp v82, v94, v82 quad_perm:[3,3,3,3] row_mask:0xf bank_mask:0xf
    v_add_f32_dpp v83, v95, v83 quad_perm:[3,3,3,3] row_mask:0xf bank_mask:0xf
    v_bfi_b32 v80, s12, v25, v80
    v_bfi_b32 v81, s12, v25, v81
    v_bfi_b32 v82, s12, v25, v82
    v_bfi_b32 v83, s12, v25, v83
    buffer_store_dwordx4 v[80:83], v5, s[44:47], 0 offen
    s_waitcnt vmcnt(1)
    s_branch F1_s2st_c
F1_s2st:
    buffer_load_dwordx4 v[74:77], v3, s[44:47], s58 offen sc1
    s_sub_u32 s8, s8, 1
    s_cbranch_scc1 L_end
    s_waitcnt vmcnt(0)
F1_s2st_c:
    v_max3_u32 v96, v74, v75, v76
    v_max_u32 v96, v96, v77
    v_cmp_eq_u32 vcc, -1, v96
    s_cbranch_vccnz F1_s2st
    v_mov_b64 v[80:81], 0
    v_mov_b64 v[84:85], 0
    v_mov_b64 v[88:89], 0
    v_mov_b64 v[96:97], 0
    v_mov_b64 v[100:101], 0
    v_mov_b32 v120, 0
    v_mov_b32 v112, s51
    v_mov_b32 v113, s51
    v_mov_b32 v114, s51
    v_mov_b32 v115, s51
    v_mov_b32 v116, s51
    v_mov_b32 v117, s51
    v_mov_b32 v118, s51
    v_mov_b32 v119, s51
    v_mov_b32 v122, s6
    v_mov_b32 v123, s6
    buffer_load_dwordx4 v[38:41], v7, s[44:47], 0 offen sc1
    buffer_load_dwordx4 v[42:45], v7, s[44:47], 0 offen offset:2048 sc1
    v_dot2_f32_bf16 v96, v74, s51, 0
    v_dot2_f32_bf16 v97, v74, v74, 0
    v_dot2_f32_bf16 v96, v75, s51, v96
    v_dot2_f32_bf16 v97, v75, v75, v97
    v_dot2_f32_bf16 v96, v76, s51, v96
    v_dot2_f32_bf16 v97, v76, v76, v97
    v_dot2_f32_bf16 v96, v77, s51, v96
    v_dot2_f32_bf16 v97, v77, v77, v97
    v_mov_b32 v98, 0x3b000000
    s_nop 0
    v_add_f32_dpp v96, v96, v96 quad_perm:[1,0,3,2] row_mask:0xf bank_mask:0xf
    v_add_f32_dpp v97, v97, v97 quad_perm:[1,0,3,2] row_mask:0xf bank_mask:0xf
    s_nop 0
    v_add_f32_dpp v96, v96, v96 quad_perm:[2,3,0,1] row_mask:0xf bank_mask:0xf
    v_add_f32_dpp v97, v97, v97 quad_perm:[2,3,0,1] row_mask:0xf bank_mask:0xf
    s_nop 0
    v_add_f32_dpp v96, v96, v96 row_half_mirror row_mask:0xf bank_mask:0xf
    v_add_f32_dpp v97, v97, v97 row_half_mirror row_mask:0xf bank_mask:0xf
    s_nop 0
    v_add_f32_dpp v96, v96, v96 row_mirror row_mask:0xf bank_mask:0xf
    v_add_f32_dpp v97, v97, v97 row_mirror row_mask:0xf bank_mask:0xf
    s_nop 0
    v_add_f32_dpp v96, v96, v96 row_bcast:15 row_mask:0xa bank_mask:0xf
    v_add_f32_dpp v97, v97, v97 row_bcast:15 row_mask:0xa bank_mask:0xf
    s_nop 0
    v_add_f32_dpp v96, v96, v96 row_bcast:31 row_mask:0xc bank_mask:0xf
    v_add_f32_dpp v97, v97, v97 row_bcast:31 row_mask:0xc bank_mask:0xf
    v_readlane_b32 s9, v96, 63
    v_readlane_b32 s10, v97, 63
    s_nop 0
    v_mul_f32 v96, s9, v98
    v_mul_f32 v97, s10, v98
    v_fma_f32 v97, -v96, v96, v97
    v_max_f32 v97, 0, v97
    v_add_f32 v97, 0x3727c5ac, v97
    v_rsq_f32 v33, v97
    s_nop 0
    v_mul_f32 v33, 0x3e0293ee, v33
    v_mul_f32 v78, -v96, v33
    v_mul_f32 v31, v78, v26
    v_mul_f32 v32, v78, v27
    v_mov_b64 v[96:97], 0
    s_mov_b64 vcc, -1
F1_s2poll:
    s_mov_b64 exec, vcc
    buffer_load_dwordx4 v[38:41], v7, s[44:47], 0 offen sc1
    buffer_load_dwordx4 v[42:45], v7, s[44:47], 0 offen offset:2048 sc1
    s_mov_b64 exec, -1
    s_sub_u32 s8, s8, 1
    s_cbranch_scc1 L_end
    s_waitcnt vmcnt(2)
    v_bitop3_b32 v124, v38, v39, s6 bitop3:0x7e
    v_bitop3_b32 v125, v40, v41, s6 bitop3:0x7e
    v_bitop3_b32 v126, v42, v43, s6 bitop3:0x7e
    v_bitop3_b32 v127, v44, v45, s6 bitop3:0x7e
    v_pk_add_f32 v[72:73], v[38:39], v[42:43]
    v_pk_add_f32 v[74:75], v[40:41], v[44:45]
    v_or3_b32 v124, v124, v125, v126
    v_bitop3_b32 v124, v124, v127, s12 bitop3:0xa8
    v_permlane32_swap_b32 v72, v74
    v_permlane32_swap_b32 v73, v75
    v_cmp_ne_u32 vcc, 0, v124
    v_add_f32 v76, v72, v74
    v_add_f32 v77, v73, v75
    v_fma_f32 v76, v76, v33, v31
    v_fma_f32 v77, v77, v33, v32
    v_cvt_pk_bf16_f32 v76, v76, v77
    ds_write_b32 v17, v76
    s_cbranch_vccnz F1_s2poll
    s_waitcnt lgkmcnt(0)
    s_barrier
    ds_read_b128 v[64:67], v18 offset:0
    ds_read_b128 v[68:71], v18 offset:64
    s_waitcnt lgkmcnt(1)
    v_smfmac_f32_16x16x64_bf16 v[80:83], v[64:67], v[184:191], v52
    v_smfmac_f32_16x16x64_bf16 v[84:87], v[64:67], v[200:207], v52
    s_waitcnt lgkmcnt(0)
    v_smfmac_f32_16x16x64_bf16 v[80:83], v[68:71], v[192:199], v52
    v_smfmac_f32_16x16x64_bf16 v[84:87], v[68:71], v[208:215], v52
    s_nop 6
    v_add_f32 v72, v80, v81
    v_add_f32 v73, v84, v85
    v_exp_f32 v74, v72
    v_exp_f32 v75, v73
    v_max_f32 v76, |v72|, |v73|
    v_cvt_pk_bf16_f32 v74, v74, v75
    v_cmp_nge_f32 vcc, s65, v76
    ds_write_b32 v19, v74
    s_cbranch_vccnz F1_mx
F1_mxr:
    s_waitcnt lgkmcnt(0)
    s_barrier
    ds_read_b128 v[64:67], v53 offset:0
    ds_read_b128 v[68:71], v53 offset:128
    ds_read_b128 v[72:75], v21 offset:64
    s_waitcnt lgkmcnt(2)
    v_smfmac_f32_16x16x64_bf16 v[88:91], v[64:67], v[112:119], v52
    v_smfmac_f32_16x16x64_bf16 v[96:99], v[64:67], v[216:223], v52
    s_waitcnt lgkmcnt(0)
    v_smfmac_f32_16x16x64_bf16 v[88:91], v[68:71], v[112:119], v52
    v_or3_b32 v78, v72, v73, v74
    v_smfmac_f32_16x16x64_bf16 v[100:103], v[64:67], v[224:231], v52
    v_or_b32 v78, v78, v75
    v_smfmac_f32_16x16x64_bf16 v[96:99], v[68:71], v[232:239], v52
    v_cmp_ne_u32 vcc, 0, v78
    v_smfmac_f32_16x16x64_bf16 v[100:103], v[68:71], v[240:247], v52
    s_nop 1
    v_add_f32 v121, v88, v89
    s_cbranch_vccnz F1_pv
    buffer_store_dwordx4 v[120:123], v9, s[44:47], 0 offen
    s_nop 0
    v_add_f32 v76, v96, v97
    s_nop 0
    v_add_f32 v77, v100, v101
F1_pvr:
    v_cvt_pk_bf16_f32 v76, v76, v77
    v_min_u32 v76, -2, v76
    buffer_store_dword v76, v10, s[44:47], 0 offen
    v_and_b32 v88, s51, v48
    v_and_b32 v89, s51, v49
    v_and_b32 v90, s51, v50
    v_and_b32 v91, s51, v51
    s_nop 15
    s_nop 7
    buffer_load_dwordx3 v[124:126], v11, s[44:47], 0 offen sc1
    buffer_load_dwordx4 v[38:41], v12, s[44:47], 0 offen sc1
    buffer_load_dwordx4 v[42:45], v12, s[44:47], 0 offen offset:1024 sc1
    s_nop 7
    s_mov_b64 vcc, -1
F1_s3poll:
    s_mov_b64 exec, vcc
    buffer_load_dwordx3 v[124:126], v11, s[44:47], 0 offen sc1
    buffer_load_dwordx4 v[38:41], v12, s[44:47], 0 offen sc1
    buffer_load_dwordx4 v[42:45], v12, s[44:47], 0 offen offset:1024 sc1
    s_mov_b64 exec, -1
    s_sub_u32 s8, s8, 1
    s_cbranch_scc1 L_end
    s_waitcnt vmcnt(5)
    v_cmp_ne_u32 s[10:11], s6, v126
    v_mov_b64 v[64:65], v[124:125]
    v_add_f32_dpp v85, v125, v125 quad_perm:[1,0,3,2] row_mask:0xf bank_mask:0xf
    v_cmp_ne_u32 s[20:21], 0, v64
    s_nop 0
    v_add_f32_dpp v85, v85, v85 quad_perm:[2,3,0,1] row_mask:0xf bank_mask:0xf
    s_waitcnt vmcnt(3)
    v_max3_u32 v86, v38, v39, v40
    v_max3_u32 v76, v41, v42, v43
    v_max_u32 v77, v44, v45
    v_mfma_f32_16x16x32_bf16 v[80:83], v[88:91], v[38:41], 0
    v_add_f32_dpp v85, v85, v85 row_half_mirror row_mask:0xf bank_mask:0xf
    v_mfma_f32_16x16x32_bf16 v[80:83], v[88:91], v[42:45], v[80:83]
    v_max3_u32 v86, v86, v76, v77
    v_rcp_f32 v85, v85
    v_cmp_ne_u64 vcc, v[64:65], v[124:125]
    v_cmp_eq_u32 s[22:23], -1, v86
    s_or_b64 vcc, vcc, s[10:11]
    s_nop 2
    v_mul_f32 v80, v80, v85
    v_mul_f32 v81, v81, v85
    s_or_b64 vcc, vcc, s[22:23]
    v_cvt_pk_bf16_f32 v80, v80, v81
    s_cmp_lg_u64 s[20:21], 0
    ds_write_b32 v54, v80
    s_cbranch_vccnz F1_s3poll
    s_cbranch_scc1 F1_wg
F1_wgr:
    s_waitcnt lgkmcnt(0)
    s_barrier
    ds_read_b128 v[64:67], v22 offset:0
    ds_read_b128 v[68:71], v22 offset:64
    ds_read_b128 v[72:75], v22 offset:128
    ds_read_b128 v[76:79], v22 offset:192
    s_mov_b32 s56, 0x80000
    s_waitcnt lgkmcnt(3)
    v_mfma_f32_16x16x32_bf16 v[80:83], v[64:67], v[160:163], 0
    s_waitcnt lgkmcnt(2)
    v_mfma_f32_16x16x32_bf16 v[80:83], v[68:71], v[164:167], v[80:83]
    s_waitcnt lgkmcnt(1)
    v_mfma_f32_16x16x32_bf16 v[80:83], v[72:75], v[168:171], v[80:83]
    s_waitcnt lgkmcnt(0)
    v_mfma_f32_16x16x32_bf16 v[80:83], v[76:79], v[172:175], v[80:83]
    s_nop 7
    v_cvt_pk_bf16_f32 v84, v80, v81
    v_cvt_pk_bf16_f32 v85, v82, v83
    v_min_u32 v84, -2, v84
    v_min_u32 v85, -2, v85
    buffer_store_dwordx2 v[84:85], v252, s[40:43], s56 offen sc1
    s_mov_b32 s58, 0xd000
    s_cmp_lg_u32 s5, 0
    s_cbranch_scc1 F1_s4_oth
    s_and_b32 s56, s50, 1
    s_lshl_b32 s56, s56, 14
    s_add_u32 s56, s56, 0x80000
    s_sleep 8
    s_xor_b32 s11, s56, 0x4000
    buffer_load_dwordx4 v[64:67], v253, s[40:43], s56 offen offset:0 sc1
    buffer_load_dwordx4 v[68:71], v253, s[40:43], s56 offen offset:1024 sc1
    buffer_load_dwordx4 v[72:75], v253, s[40:43], s56 offen offset:2048 sc1
    buffer_load_dwordx4 v[76:79], v253, s[40:43], s56 offen offset:3072 sc1
    s_sleep 4
    buffer_load_dwordx4 v[112:115], v253, s[40:43], s11 offen offset:0 sc1
    buffer_load_dwordx4 v[116:119], v253, s[40:43], s11 offen offset:1024 sc1
    buffer_load_dwordx4 v[120:123], v253, s[40:43], s11 offen offset:2048 sc1
    buffer_load_dwordx4 v[124:127], v253, s[40:43], s11 offen offset:3072 sc1
    s_waitcnt vmcnt(7)
    v_mfma_f32_16x16x32_bf16 v[80:83], v[248:251], v[64:67], 0
    v_max3_u32 v84, v64, v65, v66
    v_mov_b32 v85, v67
    s_waitcnt vmcnt(6)
    v_mfma_f32_16x16x32_bf16 v[80:83], v[248:251], v[68:71], v[80:83]
    v_max3_u32 v84, v84, v68, v69
    v_max3_u32 v85, v85, v70, v71
    s_waitcnt vmcnt(5)
    v_mfma_f32_16x16x32_bf16 v[80:83], v[248:251], v[72:75], v[80:83]
    v_max3_u32 v84, v84, v72, v73
    v_max3_u32 v85, v85, v74, v75
    s_waitcnt vmcnt(4)
    v_mfma_f32_16x16x32_bf16 v[80:83], v[248:251], v[76:79], v[80:83]
    v_max3_u32 v84, v84, v76, v77
    v_max3_u32 v85, v85, v78, v79
    v_max_u32 v84, v84, v85
    v_cmp_eq_u32 vcc, -1, v84
    s_nop 3
    v_add_f32_dpp v80, v80, v80 row_ror:8 row_mask:0xf bank_mask:0xf
    v_add_f32_dpp v81, v81, v81 row_ror:8 row_mask:0xf bank_mask:0xf
    s_cbranch_vccnz F1_s4_b
F1_s4_ok:
    v_cvt_pk_bf16_f32 v80, v80, v81
    v_and_b32 v81, 0xffff0000, v80
    v_lshlrev_b32 v80, 16, v80
    v_add_f32 v81, v81, v30
    v_add_f32 v80, v80, v255
    v_cvt_pk_bf16_f32 v80, v80, v81
    v_min_u32 v81, -2, v80
    buffer_store_dword v81, v254, s[44:47], s58 offen
    v_lshlrev_b32 v255, 16, v80
    v_and_b32 v30, 0xffff0000, v80
    s_branch F1_s4_oth
F1_s4_b:
    buffer_load_dwordx4 v[64:67], v253, s[40:43], s56 offen offset:0 sc1
    buffer_load_dwordx4 v[68:71], v253, s[40:43], s56 offen offset:1024 sc1
    buffer_load_dwordx4 v[72:75], v253, s[40:43], s56 offen offset:2048 sc1
    buffer_load_dwordx4 v[76:79], v253, s[40:43], s56 offen offset:3072 sc1
    s_waitcnt vmcnt(7)
    v_mfma_f32_16x16x32_bf16 v[80:83], v[248:251], v[112:115], 0
    v_max3_u32 v84, v112, v113, v114
    v_mov_b32 v85, v115
    s_waitcnt vmcnt(6)
    v_mfma_f32_16x16x32_bf16 v[80:83], v[248:251], v[116:119], v[80:83]
    v_max3_u32 v84, v84, v116, v117
    v_max3_u32 v85, v85, v118, v119
    s_waitcnt vmcnt(5)
    v_mfma_f32_16x16x32_bf16 v[80:83], v[248:251], v[120:123], v[80:83]
    v_max3_u32 v84, v84, v120, v121
    v_max3_u32 v85, v85, v122, v123
    s_waitcnt vmcnt(4)
    v_mfma_f32_16x16x32_bf16 v[80:83], v[248:251], v[124:127], v[80:83]
    v_max3_u32 v84, v84, v124, v125
    v_max3_u32 v85, v85, v126, v127
    v_max_u32 v84, v84, v85
    v_cmp_eq_u32 vcc, -1, v84
    s_nop 3
    v_add_f32_dpp v80, v80, v80 row_ror:8 row_mask:0xf bank_mask:0xf
    v_add_f32_dpp v81, v81, v81 row_ror:8 row_mask:0xf bank_mask:0xf
    s_cbranch_vccz F1_s4_ok
    buffer_load_dwordx4 v[112:115], v253, s[40:43], s11 offen offset:0 sc1
    buffer_load_dwordx4 v[116:119], v253, s[40:43], s11 offen offset:1024 sc1
    buffer_load_dwordx4 v[120:123], v253, s[40:43], s11 offen offset:2048 sc1
    buffer_load_dwordx4 v[124:127], v253, s[40:43], s11 offen offset:3072 sc1
    s_sub_u32 s8, s8, 1
    s_cbranch_scc1 L_end
    s_waitcnt vmcnt(7)
    v_mfma_f32_16x16x32_bf16 v[80:83], v[248:251], v[64:67], 0
    v_max3_u32 v84, v64, v65, v66
    v_mov_b32 v85, v67
    s_waitcnt vmcnt(6)
    v_mfma_f32_16x16x32_bf16 v[80:83], v[248:251], v[68:71], v[80:83]
    v_max3_u32 v84, v84, v68, v69
    v_max3_u32 v85, v85, v70, v71
    s_waitcnt vmcnt(5)
    v_mfma_f32_16x16x32_bf16 v[80:83], v[248:251], v[72:75], v[80:83]
    v_max3_u32 v84, v84, v72, v73
    v_max3_u32 v85, v85, v74, v75
    s_waitcnt vmcnt(4)
    v_mfma_f32_16x16x32_bf16 v[80:83], v[248:251], v[76:79], v[80:83]
    v_max3_u32 v84, v84, v76, v77
    v_max3_u32 v85, v85, v78, v79
    v_max_u32 v84, v84, v85
    v_cmp_eq_u32 vcc, -1, v84
    s_nop 3
    v_add_f32_dpp v80, v80, v80 row_ror:8 row_mask:0xf bank_mask:0xf
    v_add_f32_dpp v81, v81, v81 row_ror:8 row_mask:0xf bank_mask:0xf
    s_cbranch_vccnz F1_s4_b
    s_branch F1_s4_ok
F1_s4_oth:
    s_nop 15
    s_barrier
    buffer_load_dwordx4 v[34:37], v2, s[44:47], s58 offen sc1
    s_nop 15
    buffer_load_dwordx4 v[34:37], v2, s[44:47], s58 offen sc1
    s_nop 15
F1_s5:
    buffer_load_dwordx4 v[34:37], v2, s[44:47], s58 offen sc1
    s_sub_u32 s8, s8, 1
    s_cbranch_scc1 L_end
    s_waitcnt vmcnt(2)
    v_max3_u32 v72, v34, v35, v36
    v_max_u32 v72, v72, v37
    v_mfma_f32_16x16x32_bf16 v[80:83], v[144:147], v[34:37], 0
    v_cmp_eq_u32 vcc, -1, v72
    v_mfma_f32_16x16x32_bf16 v[84:87], v[148:151], v[34:37], 0
    v_mfma_f32_16x16x32_bf16 v[88:91], v[152:155], v[34:37], 0
    s_cbranch_vccnz F1_s5
    v_mfma_f32_16x16x32_bf16 v[92:95], v[156:159], v[34:37], 0
    buffer_load_dwordx4 v[74:77], v4, s[44:47], s58 offen sc1
    s_nop 3
    v_add_f32_dpp v80, v84, v80 quad_perm:[1,1,1,1] row_mask:0xf bank_mask:0xf
    v_add_f32_dpp v81, v85, v81 quad_perm:[1,1,1,1] row_mask:0xf bank_mask:0xf
    v_add_f32_dpp v82, v86, v82 quad_perm:[1,1,1,1] row_mask:0xf bank_mask:0xf
    v_add_f32_dpp v83, v87, v83 quad_perm:[1,1,1,1] row_mask:0xf bank_mask:0xf
    v_add_f32_dpp v80, v88, v80 quad_perm:[2,2,2,2] row_mask:0xf bank_mask:0xf
    v_add_f32_dpp v81, v89, v81 quad_perm:[2,2,2,2] row_mask:0xf bank_mask:0xf
    v_add_f32_dpp v82, v90, v82 quad_perm:[2,2,2,2] row_mask:0xf bank_mask:0xf
    v_add_f32_dpp v83, v91, v83 quad_perm:[2,2,2,2] row_mask:0xf bank_mask:0xf
    v_add_f32_dpp v80, v92, v80 quad_perm:[3,3,3,3] row_mask:0xf bank_mask:0xf
    v_add_f32_dpp v81, v93, v81 quad_perm:[3,3,3,3] row_mask:0xf bank_mask:0xf
    v_add_f32_dpp v82, v94, v82 quad_perm:[3,3,3,3] row_mask:0xf bank_mask:0xf
    v_add_f32_dpp v83, v95, v83 quad_perm:[3,3,3,3] row_mask:0xf bank_mask:0xf
    v_bfi_b32 v80, s12, v25, v80
    v_bfi_b32 v81, s12, v25, v81
    v_bfi_b32 v82, s12, v25, v82
    v_bfi_b32 v83, s12, v25, v83
    buffer_store_dwordx4 v[80:83], v6, s[44:47], 0 offen
    s_waitcnt vmcnt(1)
    s_branch F1_s6st_c
F1_s6st:
    buffer_load_dwordx4 v[74:77], v4, s[44:47], s58 offen sc1
    s_sub_u32 s8, s8, 1
    s_cbranch_scc1 L_end
    s_waitcnt vmcnt(0)
F1_s6st_c:
    v_max3_u32 v96, v74, v75, v76
    v_max_u32 v96, v96, v77
    v_cmp_eq_u32 vcc, -1, v96
    s_cbranch_vccnz F1_s6st
    v_dot2_f32_bf16 v96, v74, s51, 0
    v_dot2_f32_bf16 v97, v74, v74, 0
    v_dot2_f32_bf16 v96, v75, s51, v96
    v_dot2_f32_bf16 v97, v75, v75, v97
    v_dot2_f32_bf16 v96, v76, s51, v96
    v_dot2_f32_bf16 v97, v76, v76, v97
    v_dot2_f32_bf16 v96, v77, s51, v96
    v_dot2_f32_bf16 v97, v77, v77, v97
    v_mov_b32 v98, 0x3b000000
    buffer_load_dwordx4 v[38:41], v8, s[44:47], 0 offen sc1
    buffer_load_dwordx4 v[42:45], v8, s[44:47], 0 offen offset:256 sc1
    v_add_f32_dpp v96, v96, v96 quad_perm:[1,0,3,2] row_mask:0xf bank_mask:0xf
    v_add_f32_dpp v97, v97, v97 quad_perm:[1,0,3,2] row_mask:0xf bank_mask:0xf
    s_nop 0
    v_add_f32_dpp v96, v96, v96 quad_perm:[2,3,0,1] row_mask:0xf bank_mask:0xf
    v_add_f32_dpp v97, v97, v97 quad_perm:[2,3,0,1] row_mask:0xf bank_mask:0xf
    s_nop 0
    v_add_f32_dpp v96, v96, v96 row_half_mirror row_mask:0xf bank_mask:0xf
    v_add_f32_dpp v97, v97, v97 row_half_mirror row_mask:0xf bank_mask:0xf
    s_nop 0
    v_add_f32_dpp v96, v96, v96 row_mirror row_mask:0xf bank_mask:0xf
    v_add_f32_dpp v97, v97, v97 row_mirror row_mask:0xf bank_mask:0xf
    s_nop 0
    v_add_f32_dpp v96, v96, v96 row_bcast:15 row_mask:0xa bank_mask:0xf
    v_add_f32_dpp v97, v97, v97 row_bcast:15 row_mask:0xa bank_mask:0xf
    s_nop 0
    v_add_f32_dpp v96, v96, v96 row_bcast:31 row_mask:0xc bank_mask:0xf
    v_add_f32_dpp v97, v97, v97 row_bcast:31 row_mask:0xc bank_mask:0xf
    v_readlane_b32 s9, v96, 63
    v_readlane_b32 s10, v97, 63
    s_nop 0
    v_mul_f32 v96, s9, v98
    v_mul_f32 v97, s10, v98
    v_fma_f32 v97, -v96, v96, v97
    v_max_f32 v97, 0, v97
    v_add_f32 v97, 0x3727c5ac, v97
    v_rsq_f32 v33, v97
    s_nop 0
    v_mul_f32 v78, -v96, v33
    v_mul_f32 v31, v78, v28
    v_mul_f32 v32, v78, v29
    v_mul_f32 v94, 0xbfb8aa3b, v33
    v_mul_f32 v95, 0xbfb8aa3b, v31
    s_mov_b32 s56, 0x100000
    s_mov_b64 vcc, -1
F1_s6poll:
    s_mov_b64 exec, vcc
    buffer_load_dwordx4 v[38:41], v8, s[44:47], 0 offen sc1
    buffer_load_dwordx4 v[42:45], v8, s[44:47], 0 offen offset:256 sc1
    s_mov_b64 exec, -1
    s_sub_u32 s8, s8, 1
    s_cbranch_scc1 L_end
    s_waitcnt vmcnt(2)
    v_bitop3_b32 v80, v38, v39, s6 bitop3:0x7e
    v_bitop3_b32 v81, v40, v41, s6 bitop3:0x7e
    v_bitop3_b32 v82, v42, v43, s6 bitop3:0x7e
    v_bitop3_b32 v83, v44, v45, s6 bitop3:0x7e
    v_pk_add_f32 v[72:73], v[38:39], v[42:43]
    v_pk_add_f32 v[74:75], v[40:41], v[44:45]
    v_or3_b32 v80, v80, v81, v82
    v_bitop3_b32 v80, v80, v83, s12 bitop3:0xa8
    v_permlane16_swap_b32 v72, v74
    v_permlane16_swap_b32 v73, v75
    v_cmp_ne_u32 vcc, 0, v80
    v_add_f32 v72, v72, v74
    v_add_f32 v74, v73, v75
    s_nop 1
    v_permlane32_swap_b32 v72, v74
    v_fma_f32 v73, v72, v94, v95
    s_cbranch_vccnz F1_s6poll
    v_exp_f32 v73, v73
    v_fma_f32 v72, v72, v33, v31
    v_add_f32 v73, 1.0, v73
    v_fma_f32 v74, v74, v33, v32
    v_rcp_f32 v73, v73
    v_mul_f32 v74, v74, v72
    v_mul_f32 v72, v74, v73
    v_cvt_pk_bf16_f32 v72, v72, v72
    ds_write_b16 v23, v72
    s_waitcnt lgkmcnt(0)
    s_barrier
    ds_read_b128 v[64:67], v24 offset:0
    ds_read_b128 v[68:71], v24 offset:64
    s_waitcnt lgkmcnt(1)
    v_mfma_f32_16x16x32_bf16 v[80:83], v[64:67], v[176:179], 0
    s_waitcnt lgkmcnt(0)
    v_mfma_f32_16x16x32_bf16 v[80:83], v[68:71], v[180:183], v[80:83]
    s_nop 7
    v_cvt_pk_bf16_f32 v84, v80, v81
    v_cvt_pk_bf16_f32 v85, v82, v83
    v_min_u32 v84, -2, v84
    v_min_u32 v85, -2, v85
    buffer_store_dwordx2 v[84:85], v14, s[40:43], s56 offen sc1
    s_cmp_lg_u32 s52, 0
    s_cbranch_scc1 L_finish2
    s_cmp_lg_u32 s5, 0
    s_cbranch_scc1 L_finish2
    s_mov_b32 s56, 0x100000
    s_sleep 8
    s_xor_b32 s11, s56, 0x4000
    buffer_load_dwordx4 v[64:67], v253, s[40:43], s56 offen offset:0 sc1
    buffer_load_dwordx4 v[68:71], v253, s[40:43], s56 offen offset:1024 sc1
    buffer_load_dwordx4 v[72:75], v253, s[40:43], s56 offen offset:2048 sc1
    buffer_load_dwordx4 v[76:79], v253, s[40:43], s56 offen offset:3072 sc1
    s_sleep 4
    buffer_load_dwordx4 v[112:115], v253, s[40:43], s11 offen offset:0 sc1
    buffer_load_dwordx4 v[116:119], v253, s[40:43], s11 offen offset:1024 sc1
    buffer_load_dwordx4 v[120:123], v253, s[40:43], s11 offen offset:2048 sc1
    buffer_load_dwordx4 v[124:127], v253, s[40:43], s11 offen offset:3072 sc1
    s_waitcnt vmcnt(7)
    v_mfma_f32_16x16x32_bf16 v[80:83], v[248:251], v[64:67], 0
    v_max3_u32 v84, v64, v65, v66
    v_mov_b32 v85, v67
    s_waitcnt vmcnt(6)
    v_mfma_f32_16x16x32_bf16 v[80:83], v[248:251], v[68:71], v[80:83]
    v_max3_u32 v84, v84, v68, v69
    v_max3_u32 v85, v85, v70, v71
    s_waitcnt vmcnt(5)
    v_mfma_f32_16x16x32_bf16 v[80:83], v[248:251], v[72:75], v[80:83]
    v_max3_u32 v84, v84, v72, v73
    v_max3_u32 v85, v85, v74, v75
    s_waitcnt vmcnt(4)
    v_mfma_f32_16x16x32_bf16 v[80:83], v[248:251], v[76:79], v[80:83]
    v_max3_u32 v84, v84, v76, v77
    v_max3_u32 v85, v85, v78, v79
    v_max_u32 v84, v84, v85
    v_cmp_eq_u32 vcc, -1, v84
    s_nop 3
    v_add_f32_dpp v80, v80, v80 row_ror:8 row_mask:0xf bank_mask:0xf
    v_add_f32_dpp v81, v81, v81 row_ror:8 row_mask:0xf bank_mask:0xf
    s_cbranch_vccnz F1_s7_b
F1_s7_ok:
    v_cvt_pk_bf16_f32 v80, v80, v81
    v_and_b32 v81, 0xffff0000, v80
    v_lshlrev_b32 v80, 16, v80
    v_add_f32 v81, v81, v30
    v_add_f32 v80, v80, v255
    v_cvt_pk_bf16_f32 v80, v80, v81
    buffer_store_dword v80, v254, s[16:19], 0 offen
L_finish:
    v_cmp_eq_u32 vcc, 0, v0
    s_cmp_lg_u32 s2, 0
    s_cbranch_scc1 L_finish2
    v_mov_b32 v92, 0
    s_and_saveexec_b64 s[10:11], vcc
    s_cbranch_execz L_noep
    global_store_dword v92, v25, s[38:39]
L_noep:
    s_mov_b64 exec, -1
L_finish2:
L_end:
    s_endpgm
F1_s7_b:
    buffer_load_dwordx4 v[64:67], v253, s[40:43], s56 offen offset:0 sc1
    buffer_load_dwordx4 v[68:71], v253, s[40:43], s56 offen offset:1024 sc1
    buffer_load_dwordx4 v[72:75], v253, s[40:43], s56 offen offset:2048 sc1
    buffer_load_dwordx4 v[76:79], v253, s[40:43], s56 offen offset:3072 sc1
    s_waitcnt vmcnt(7)
    v_mfma_f32_16x16x32_bf16 v[80:83], v[248:251], v[112:115], 0
    v_max3_u32 v84, v112, v113, v114
    v_mov_b32 v85, v115
    s_waitcnt vmcnt(6)
    v_mfma_f32_16x16x32_bf16 v[80:83], v[248:251], v[116:119], v[80:83]
    v_max3_u32 v84, v84, v116, v117
    v_max3_u32 v85, v85, v118, v119
    s_waitcnt vmcnt(5)
    v_mfma_f32_16x16x32_bf16 v[80:83], v[248:251], v[120:123], v[80:83]
    v_max3_u32 v84, v84, v120, v121
    v_max3_u32 v85, v85, v122, v123
    s_waitcnt vmcnt(4)
    v_mfma_f32_16x16x32_bf16 v[80:83], v[248:251], v[124:127], v[80:83]
    v_max3_u32 v84, v84, v124, v125
    v_max3_u32 v85, v85, v126, v127
    v_max_u32 v84, v84, v85
    v_cmp_eq_u32 vcc, -1, v84
    s_nop 3
    v_add_f32_dpp v80, v80, v80 row_ror:8 row_mask:0xf bank_mask:0xf
    v_add_f32_dpp v81, v81, v81 row_ror:8 row_mask:0xf bank_mask:0xf
    s_cbranch_vccz F1_s7_ok
    buffer_load_dwordx4 v[112:115], v253, s[40:43], s11 offen offset:0 sc1
    buffer_load_dwordx4 v[116:119], v253, s[40:43], s11 offen offset:1024 sc1
    buffer_load_dwordx4 v[120:123], v253, s[40:43], s11 offen offset:2048 sc1
    buffer_load_dwordx4 v[124:127], v253, s[40:43], s11 offen offset:3072 sc1
    s_sub_u32 s8, s8, 1
    s_cbranch_scc1 L_end
    s_waitcnt vmcnt(7)
    v_mfma_f32_16x16x32_bf16 v[80:83], v[248:251], v[64:67], 0
    v_max3_u32 v84, v64, v65, v66
    v_mov_b32 v85, v67
    s_waitcnt vmcnt(6)
    v_mfma_f32_16x16x32_bf16 v[80:83], v[248:251], v[68:71], v[80:83]
    v_max3_u32 v84, v84, v68, v69
    v_max3_u32 v85, v85, v70, v71
    s_waitcnt vmcnt(5)
    v_mfma_f32_16x16x32_bf16 v[80:83], v[248:251], v[72:75], v[80:83]
    v_max3_u32 v84, v84, v72, v73
    v_max3_u32 v85, v85, v74, v75
    s_waitcnt vmcnt(4)
    v_mfma_f32_16x16x32_bf16 v[80:83], v[248:251], v[76:79], v[80:83]
    v_max3_u32 v84, v84, v76, v77
    v_max3_u32 v85, v85, v78, v79
    v_max_u32 v84, v84, v85
    v_cmp_eq_u32 vcc, -1, v84
    s_nop 3
    v_add_f32_dpp v80, v80, v80 row_ror:8 row_mask:0xf bank_mask:0xf
    v_add_f32_dpp v81, v81, v81 row_ror:8 row_mask:0xf bank_mask:0xf
    s_cbranch_vccnz F1_s7_b
    s_branch F1_s7_ok
F0_l13:
F0_s13:
    s_mov_b64 exec, 1
    ds_read_b32 v64, v59 offset:16
    s_mov_b64 exec, -1
    s_sub_u32 s8, s8, 1
    s_cbranch_scc1 L_end
    s_waitcnt lgkmcnt(0)
    v_readfirstlane_b32 s9, v64
    s_cmp_lt_u32 s9, 6
    s_cbranch_scc1 F0_s13
    ds_read_b64_tr_b16 v[144:145], v56 offset:32768
    ds_read_b64_tr_b16 v[146:147], v56 offset:33280
    ds_read_b64_tr_b16 v[148:149], v56 offset:33792
    ds_read_b64_tr_b16 v[150:151], v56 offset:34304
    ds_read_b64_tr_b16 v[152:153], v56 offset:34816
    ds_read_b64_tr_b16 v[154:155], v56 offset:35328
    ds_read_b64_tr_b16 v[156:157], v56 offset:35840
    ds_read_b64_tr_b16 v[158:159], v56 offset:36352
    v_mov_b32 v100, s51
    v_mov_b32 v101, s51
    v_mov_b32 v102, s51
    v_mov_b32 v103, s51
    s_waitcnt lgkmcnt(0)
    s_nop 0
    v_mfma_f32_16x16x32_bf16 v[96:99], v[144:147], v[100:103], 0
    v_mfma_f32_16x16x32_bf16 v[96:99], v[148:151], v[100:103], v[96:99]
    v_mfma_f32_16x16x32_bf16 v[96:99], v[152:155], v[100:103], v[96:99]
    v_mfma_f32_16x16x32_bf16 v[96:99], v[156:159], v[100:103], v[96:99]
    s_nop 7
    v_bfi_b32 v96, s12, v25, v96
    v_bfi_b32 v97, s12, v25, v97
    v_bfi_b32 v98, s12, v25, v98
    v_bfi_b32 v99, s12, v25, v99
    buffer_store_dwordx4 v[96:99], v46, s[44:47], 0 offen
    s_branch F0_l13r
L_ld2:
    s_waitcnt vmcnt(19)
    global_load_lds_dwordx4 v71, s[22:23] nt
    s_mov_b32 m0, 78848
    v_add_u32 v71, 0x10000, v71
    s_waitcnt vmcnt(19)
    global_load_lds_dwordx4 v71, s[22:23] nt
    s_mov_b32 m0, 79872
    v_add_u32 v71, 0x10000, v71
    s_waitcnt vmcnt(19)
    global_load_lds_dwordx4 v71, s[22:23] nt
    s_mov_b32 m0, 80896
    v_add_u32 v71, 0x10000, v71
    s_waitcnt vmcnt(19)
    global_load_lds_dwordx4 v71, s[22:23] nt
    s_lshl_b32 s9, s15, 3
    s_add_u32 s9, s9, s3
    s_lshl_b32 s9, s9, 20
    s_lshl_b32 s10, s14, 15
    s_add_u32 s54, s9, s10
    s_add_u32 s54, s54, 786432
    s_lshl_b32 s48, s3, 2
    s_xor_b32 s48, s48, s4
    s_lshl_b32 s53, s48, 10
    s_xor_b32 s54, s54, s53
    v_lshrrev_b32 v78, 4, v1
    v_lshrrev_b32 v79, 5, v1
    v_xor_b32 v70, v64, v79
    v_lshlrev_b32 v70, 4, v70
    v_lshl_add_u32 v70, v78, 8, v70
    s_and_b32 s9, s48, 7
    s_lshl_b32 s9, s9, 5
    s_xor_b32 s9, s9, s54
    v_xor_b32 v70, s9, v70
    s_xor_b32 m0, s53, 0
    s_waitcnt vmcnt(19)
    v_mov_b32 v60, 1
    s_mov_b64 exec, 1
    ds_write_b32 v59, v60 offset:16
    s_mov_b64 exec, -1
    global_load_lds_dwordx4 v70, s[18:19] nt
    s_xor_b32 m0, m0, 1024
    v_xor_b32 v70, 1056, v70
    s_waitcnt vmcnt(19)
    global_load_lds_dwordx4 v70, s[18:19] nt
    s_xor_b32 m0, m0, 3072
    v_xor_b32 v70, 3168, v70
    s_waitcnt vmcnt(19)
    global_load_lds_dwordx4 v70, s[18:19] nt
    s_xor_b32 m0, m0, 1024
    v_xor_b32 v70, 1056, v70
    s_waitcnt vmcnt(19)
    global_load_lds_dwordx4 v70, s[18:19] nt
    s_xor_b32 m0, m0, 7168
    v_xor_b32 v70, 7392, v70
    s_waitcnt vmcnt(19)
    global_load_lds_dwordx4 v70, s[18:19] nt
    s_xor_b32 m0, m0, 1024
    v_xor_b32 v70, 1056, v70
    s_waitcnt vmcnt(19)
    global_load_lds_dwordx4 v70, s[18:19] nt
    s_xor_b32 m0, m0, 3072
    v_xor_b32 v70, 3168, v70
    s_waitcnt vmcnt(19)
    global_load_lds_dwordx4 v70, s[18:19] nt
    s_xor_b32 m0, m0, 1024
    v_xor_b32 v70, 1056, v70
    s_waitcnt vmcnt(19)
    global_load_lds_dwordx4 v70, s[18:19] nt
    s_xor_b32 m0, m0, 15360
    v_xor_b32 v70, 15584, v70
    s_waitcnt vmcnt(19)
    global_load_lds_dwordx4 v70, s[18:19] nt
    s_xor_b32 m0, m0, 1024
    v_xor_b32 v70, 1056, v70
    s_waitcnt vmcnt(19)
    global_load_lds_dwordx4 v70, s[18:19] nt
    s_xor_b32 m0, m0, 3072
    v_xor_b32 v70, 3168, v70
    s_waitcnt vmcnt(19)
    global_load_lds_dwordx4 v70, s[18:19] nt
    s_xor_b32 m0, m0, 1024
    v_xor_b32 v70, 1056, v70
    s_waitcnt vmcnt(19)
    global_load_lds_dwordx4 v70, s[18:19] nt
    s_xor_b32 m0, m0, 7168
    v_xor_b32 v70, 7392, v70
    s_waitcnt vmcnt(19)
    global_load_lds_dwordx4 v70, s[18:19] nt
    s_xor_b32 m0, m0, 1024
    v_xor_b32 v70, 1056, v70
    s_waitcnt vmcnt(19)
    global_load_lds_dwordx4 v70, s[18:19] nt
    s_xor_b32 m0, m0, 3072
    v_xor_b32 v70, 3168, v70
    s_waitcnt vmcnt(19)
    global_load_lds_dwordx4 v70, s[18:19] nt
    s_xor_b32 m0, m0, 1024
    v_xor_b32 v70, 1056, v70
    s_waitcnt vmcnt(19)
    global_load_lds_dwordx4 v70, s[18:19] nt
    s_xor_b32 m0, m0, 31744
    v_xor_b32 v70, 31968, v70
    s_waitcnt vmcnt(19)
    global_load_lds_dwordx4 v70, s[18:19] nt
    s_xor_b32 m0, m0, 1024
    v_xor_b32 v70, 1056, v70
    s_waitcnt vmcnt(19)
    global_load_lds_dwordx4 v70, s[18:19] nt
    s_xor_b32 m0, m0, 3072
    v_xor_b32 v70, 3168, v70
    s_waitcnt vmcnt(19)
    global_load_lds_dwordx4 v70, s[18:19] nt
    s_xor_b32 m0, m0, 1024
    v_xor_b32 v70, 1056, v70
    s_waitcnt vmcnt(19)
    v_mov_b32 v60, 2
    s_mov_b64 exec, 1
    ds_write_b32 v59, v60 offset:16
    s_mov_b64 exec, -1
    global_load_lds_dwordx4 v70, s[18:19] nt
    s_xor_b32 m0, m0, 7168
    v_xor_b32 v70, 7392, v70
    s_waitcnt vmcnt(19)
    global_load_lds_dwordx4 v70, s[18:19] nt
    s_xor_b32 m0, m0, 1024
    v_xor_b32 v70, 1056, v70
    s_waitcnt vmcnt(19)
    global_load_lds_dwordx4 v70, s[18:19] nt
    s_xor_b32 m0, m0, 3072
    v_xor_b32 v70, 3168, v70
    s_waitcnt vmcnt(19)
    global_load_lds_dwordx4 v70, s[18:19] nt
    s_xor_b32 m0, m0, 1024
    v_xor_b32 v70, 1056, v70
    s_waitcnt vmcnt(19)
    global_load_lds_dwordx4 v70, s[18:19] nt
    s_xor_b32 m0, m0, 15360
    v_xor_b32 v70, 15584, v70
    s_waitcnt vmcnt(19)
    global_load_lds_dwordx4 v70, s[18:19] nt
    s_xor_b32 m0, m0, 1024
    v_xor_b32 v70, 1056, v70
    s_waitcnt vmcnt(19)
    global_load_lds_dwordx4 v70, s[18:19] nt
    s_xor_b32 m0, m0, 3072
    v_xor_b32 v70, 3168, v70
    s_waitcnt vmcnt(19)
    global_load_lds_dwordx4 v70, s[18:19] nt
    s_xor_b32 m0, m0, 1024
    v_xor_b32 v70, 1056, v70
    s_waitcnt vmcnt(19)
    global_load_lds_dwordx4 v70, s[18:19] nt
    s_xor_b32 m0, m0, 7168
    v_xor_b32 v70, 7392, v70
    s_waitcnt vmcnt(19)
    global_load_lds_dwordx4 v70, s[18:19] nt
    s_xor_b32 m0, m0, 1024
    v_xor_b32 v70, 1056, v70
    s_waitcnt vmcnt(19)
    global_load_lds_dwordx4 v70, s[18:19] nt
    s_xor_b32 m0, m0, 3072
    v_xor_b32 v70, 3168, v70
    s_waitcnt vmcnt(19)
    global_load_lds_dwordx4 v70, s[18:19] nt
    s_xor_b32 m0, m0, 1024
    v_xor_b32 v70, 1056, v70
    s_waitcnt vmcnt(19)
    global_load_lds_dwordx4 v70, s[18:19] nt
    v_lshrrev_b32 v70, 1, v64
    v_and_b32 v71, 1, v78
    v_xor_b32 v70, v70, v71
    v_lshlrev_b32 v70, 5, v70
    v_and_b32 v71, 1, v1
    v_lshl_add_u32 v70, v71, 4, v70
    v_lshl_add_u32 v70, v78, 8, v70
    s_and_b32 s9, s48, 1
    s_lshl_b32 s9, s9, 6
    s_and_b32 s10, s48, 8
    s_lshl_b32 s10, s10, 4
    s_xor_b32 s9, s9, s10
    s_xor_b32 s9, s9, s54
    v_xor_b32 v70, s9, v70
    s_xor_b32 m0, s53, 32768
    s_waitcnt vmcnt(19)
    global_load_lds_dwordx4 v70, s[20:21] nt
    s_xor_b32 m0, m0, 1024
    v_xor_b32 v70, 1088, v70
    s_waitcnt vmcnt(19)
    global_load_lds_dwordx4 v70, s[20:21] nt
    s_xor_b32 m0, m0, 3072
    v_xor_b32 v70, 3136, v70
    s_waitcnt vmcnt(19)
    global_load_lds_dwordx4 v70, s[20:21] nt
    s_xor_b32 m0, m0, 1024
    v_xor_b32 v70, 1088, v70
    s_waitcnt vmcnt(19)
    global_load_lds_dwordx4 v70, s[20:21] nt
    s_xor_b32 m0, m0, 7168
    v_xor_b32 v70, 7232, v70
    s_waitcnt vmcnt(19)
    global_load_lds_dwordx4 v70, s[20:21] nt
    s_xor_b32 m0, m0, 1024
    v_xor_b32 v70, 1088, v70
    s_waitcnt vmcnt(19)
    global_load_lds_dwordx4 v70, s[20:21] nt
    s_xor_b32 m0, m0, 3072
    v_xor_b32 v70, 3136, v70
    s_waitcnt vmcnt(19)
    global_load_lds_dwordx4 v70, s[20:21] nt
    s_xor_b32 m0, m0, 1024
    v_xor_b32 v70, 1088, v70
    s_waitcnt vmcnt(19)
    global_load_lds_dwordx4 v70, s[20:21] nt
    s_xor_b32 m0, m0, 15360
    v_xor_b32 v70, 15552, v70
    s_waitcnt vmcnt(19)
    global_load_lds_dwordx4 v70, s[20:21] nt
    s_xor_b32 m0, m0, 1024
    v_xor_b32 v70, 1088, v70
    s_waitcnt vmcnt(19)
    global_load_lds_dwordx4 v70, s[20:21] nt
    s_xor_b32 m0, m0, 3072
    v_xor_b32 v70, 3136, v70
    s_waitcnt vmcnt(19)
    global_load_lds_dwordx4 v70, s[20:21] nt
    s_xor_b32 m0, m0, 1024
    v_xor_b32 v70, 1088, v70
    s_waitcnt vmcnt(19)
    global_load_lds_dwordx4 v70, s[20:21] nt
    s_xor_b32 m0, m0, 7168
    v_xor_b32 v70, 7232, v70
    s_waitcnt vmcnt(19)
    global_load_lds_dwordx4 v70, s[20:21] nt
    s_xor_b32 m0, m0, 1024
    v_xor_b32 v70, 1088, v70
    s_waitcnt vmcnt(19)
    global_load_lds_dwordx4 v70, s[20:21] nt
    s_xor_b32 m0, m0, 3072
    v_xor_b32 v70, 3136, v70
    s_waitcnt vmcnt(19)
    global_load_lds_dwordx4 v70, s[20:21] nt
    s_xor_b32 m0, m0, 1024
    v_xor_b32 v70, 1088, v70
    s_waitcnt vmcnt(19)
    global_load_lds_dwordx4 v70, s[20:21] nt
    s_xor_b32 m0, m0, 31744
    v_xor_b32 v70, 31936, v70
    s_waitcnt vmcnt(19)
    global_load_lds_dwordx4 v70, s[20:21] nt
    s_xor_b32 m0, m0, 1024
    v_xor_b32 v70, 1088, v70
    s_waitcnt vmcnt(19)
    global_load_lds_dwordx4 v70, s[20:21] nt
    s_xor_b32 m0, m0, 3072
    v_xor_b32 v70, 3136, v70
    s_waitcnt vmcnt(19)
    global_load_lds_dwordx4 v70, s[20:21] nt
    s_xor_b32 m0, m0, 1024
    v_xor_b32 v70, 1088, v70
    s_waitcnt vmcnt(19)
    v_mov_b32 v60, 3
    s_mov_b64 exec, 1
    ds_write_b32 v59, v60 offset:16
    s_mov_b64 exec, -1
    global_load_lds_dwordx4 v70, s[20:21] nt
    s_xor_b32 m0, m0, 7168
    v_xor_b32 v70, 7232, v70
    s_waitcnt vmcnt(19)
    global_load_lds_dwordx4 v70, s[20:21] nt
    s_xor_b32 m0, m0, 1024
    v_xor_b32 v70, 1088, v70
    s_waitcnt vmcnt(19)
    global_load_lds_dwordx4 v70, s[20:21] nt
    s_xor_b32 m0, m0, 3072
    v_xor_b32 v70, 3136, v70
    s_waitcnt vmcnt(19)
    global_load_lds_dwordx4 v70, s[20:21] nt
    s_xor_b32 m0, m0, 1024
    v_xor_b32 v70, 1088, v70
    s_waitcnt vmcnt(19)
    global_load_lds_dwordx4 v70, s[20:21] nt
    s_xor_b32 m0, m0, 15360
    v_xor_b32 v70, 15552, v70
    s_waitcnt vmcnt(19)
    global_load_lds_dwordx4 v70, s[20:21] nt
    s_xor_b32 m0, m0, 1024
    v_xor_b32 v70, 1088, v70
    s_waitcnt vmcnt(19)
    global_load_lds_dwordx4 v70, s[20:21] nt
    s_xor_b32 m0, m0, 3072
    v_xor_b32 v70, 3136, v70
    s_waitcnt vmcnt(19)
    global_load_lds_dwordx4 v70, s[20:21] nt
    s_xor_b32 m0, m0, 1024
    v_xor_b32 v70, 1088, v70
    s_waitcnt vmcnt(19)
    global_load_lds_dwordx4 v70, s[20:21] nt
    s_xor_b32 m0, m0, 7168
    v_xor_b32 v70, 7232, v70
    s_waitcnt vmcnt(19)
    global_load_lds_dwordx4 v70, s[20:21] nt
    s_xor_b32 m0, m0, 1024
    v_xor_b32 v70, 1088, v70
    s_waitcnt vmcnt(19)
    global_load_lds_dwordx4 v70, s[20:21] nt
    s_xor_b32 m0, m0, 3072
    v_xor_b32 v70, 3136, v70
    s_waitcnt vmcnt(19)
    global_load_lds_dwordx4 v70, s[20:21] nt
    s_xor_b32 m0, m0, 1024
    v_xor_b32 v70, 1088, v70
    s_waitcnt vmcnt(19)
    global_load_lds_dwordx4 v70, s[20:21] nt
    s_lshl_b32 s9, s4, 10
    s_add_u32 s9, s9, s52
    s_add_u32 s9, s9, 0x20000
    v_lshl_add_u32 v77, v69, 7, s9
    s_waitcnt vmcnt(19)
    global_load_dword v61, v77, s[38:39] sc1
    s_mul_i32 s9, s4, 2944
    s_add_u32 s9, s9, s52
    s_add_u32 s9, s9, 0x9000
    v_min_u32 v77, 22, v1
    v_lshl_add_u32 v77, v77, 7, s9
    s_lshl_b32 s9, s3, 2
    s_add_u32 s9, s9, s15
    s_lshl_b32 s9, s9, 17
    s_lshl_b32 s14, s14, 7
    s_add_u32 s9, s9, s14
    v_lshlrev_b32 v70, 1, v79
    v_xor_b32 v70, v70, v69
    v_lshlrev_b32 v70, 4, v70
    v_lshl_add_u32 v70, v67, 10, v70
    v_add_u32 v70, s9, v70
    v_xor_b32 v71, 64, v70
    s_mov_b32 m0, 81920
    s_waitcnt vmcnt(19)
    global_load_lds_dwordx4 v70, s[24:25] nt
    s_mov_b32 m0, 86016
    v_add_u32 v70, 0x2000, v70
    s_waitcnt vmcnt(19)
    global_load_lds_dwordx4 v70, s[24:25] nt
    s_mov_b32 m0, 90112
    v_add_u32 v71, 0x4000, v71
    s_waitcnt vmcnt(19)
    global_load_lds_dwordx4 v71, s[24:25] nt
    s_mov_b32 m0, 94208
    v_add_u32 v71, 0x2000, v71
    s_waitcnt vmcnt(19)
    global_load_lds_dwordx4 v71, s[24:25] nt
    s_mov_b32 m0, 82944
    v_add_u32 v70, 0x6000, v70
    s_waitcnt vmcnt(19)
    global_load_lds_dwordx4 v70, s[24:25] nt
    s_mov_b32 m0, 87040
    v_add_u32 v70, 0x2000, v70
    s_waitcnt vmcnt(19)
    global_load_lds_dwordx4 v70, s[24:25] nt
    s_mov_b32 m0, 91136
    v_add_u32 v71, 0x6000, v71
    s_waitcnt vmcnt(19)
    global_load_lds_dwordx4 v71, s[24:25] nt
    s_mov_b32 m0, 95232
    v_add_u32 v71, 0x2000, v71
    s_waitcnt vmcnt(19)
    global_load_lds_dwordx4 v71, s[24:25] nt
    s_mov_b32 m0, 83968
    v_add_u32 v70, 0x6000, v70
    s_waitcnt vmcnt(19)
    global_load_lds_dwordx4 v70, s[24:25] nt
    s_mov_b32 m0, 88064
    v_add_u32 v70, 0x2000, v70
    s_waitcnt vmcnt(19)
    global_load_lds_dwordx4 v70, s[24:25] nt
    s_mov_b32 m0, 92160
    v_add_u32 v71, 0x6000, v71
    s_waitcnt vmcnt(19)
    global_load_lds_dwordx4 v71, s[24:25] nt
    s_mov_b32 m0, 96256
    v_add_u32 v71, 0x2000, v71
    s_waitcnt vmcnt(19)
    global_load_lds_dwordx4 v71, s[24:25] nt
    s_mov_b32 m0, 84992
    v_add_u32 v70, 0x6000, v70
    s_waitcnt vmcnt(19)
    global_load_lds_dwordx4 v70, s[24:25] nt
    s_mov_b32 m0, 89088
    v_add_u32 v70, 0x2000, v70
    s_waitcnt vmcnt(19)
    global_load_lds_dwordx4 v70, s[24:25] nt
    s_mov_b32 m0, 93184
    v_add_u32 v71, 0x6000, v71
    s_waitcnt vmcnt(19)
    global_load_lds_dwordx4 v71, s[24:25] nt
    s_mov_b32 m0, 97280
    v_add_u32 v71, 0x2000, v71
    s_waitcnt vmcnt(19)
    global_load_lds_dwordx4 v71, s[24:25] nt
    s_cmp_lt_u32 s4, 16
    s_cselect_b32 s26, s28, s30
    s_cselect_b32 s27, s29, s31
    s_lshr_b32 s53, s3, 1
    s_mul_i32 s53, s53, 7
    s_and_b32 s11, s3, 1
    s_lshl_b32 s9, s11, 2
    s_add_u32 s53, s53, s9
    s_sub_u32 s11, 4, s11
    s_bfe_u32 s9, s4, 0x20002
    s_cmp_lt_u32 s9, s11
    s_cselect_b32 s9, s9, 0
    s_cmp_lt_u32 s15, s11
    s_cselect_b32 s15, s15, 0
    s_add_u32 s9, s9, s53
    s_lshl_b32 s9, s9, 7
    s_mul_i32 s10, s7, 458752
    s_add_u32 s9, s9, s10
    v_mul_u32_u24 v70, 3584, v67
    v_add3_u32 v70, v70, v68, s9
    v_xor_b32 v71, 64, v70
    s_mov_b32 m0, 98304
    s_waitcnt vmcnt(19)
    global_load_lds_dwordx4 v70, s[26:27] nt
    s_mov_b32 m0, 99328
    v_add_u32 v70, 0x7000, v70
    s_waitcnt vmcnt(19)
    global_load_lds_dwordx4 v70, s[26:27] nt
    s_mov_b32 m0, 100352
    v_add_u32 v70, 0x7000, v70
    s_waitcnt vmcnt(19)
    v_mov_b32 v60, 4
    s_mov_b64 exec, 1
    ds_write_b32 v59, v60 offset:16
    s_mov_b64 exec, -1
    global_load_lds_dwordx4 v70, s[26:27] nt
    s_mov_b32 m0, 101376
    v_add_u32 v70, 0x7000, v70
    s_waitcnt vmcnt(19)
    global_load_lds_dwordx4 v70, s[26:27] nt
    s_mov_b32 m0, 102400
    v_add_u32 v71, 0x1c000, v71
    s_waitcnt vmcnt(19)
    global_load_lds_dwordx4 v71, s[26:27] nt
    s_mov_b32 m0, 103424
    v_add_u32 v71, 0x7000, v71
    s_waitcnt vmcnt(19)
    global_load_lds_dwordx4 v71, s[26:27] nt
    s_mov_b32 m0, 104448
    v_add_u32 v71, 0x7000, v71
    s_waitcnt vmcnt(19)
    global_load_lds_dwordx4 v71, s[26:27] nt
    s_mov_b32 m0, 105472
    v_add_u32 v71, 0x7000, v71
    s_waitcnt vmcnt(19)
    global_load_lds_dwordx4 v71, s[26:27] nt
    s_mov_b32 m0, 106496
    v_add_u32 v70, 0x23000, v70
    s_waitcnt vmcnt(19)
    global_load_lds_dwordx4 v70, s[26:27] nt
    s_mov_b32 m0, 107520
    v_add_u32 v70, 0x7000, v70
    s_waitcnt vmcnt(19)
    global_load_lds_dwordx4 v70, s[26:27] nt
    s_mov_b32 m0, 108544
    v_add_u32 v70, 0x7000, v70
    s_waitcnt vmcnt(19)
    global_load_lds_dwordx4 v70, s[26:27] nt
    s_mov_b32 m0, 109568
    v_add_u32 v70, 0x7000, v70
    s_waitcnt vmcnt(19)
    global_load_lds_dwordx4 v70, s[26:27] nt
    s_mov_b32 m0, 110592
    v_add_u32 v71, 0x23000, v71
    s_waitcnt vmcnt(19)
    global_load_lds_dwordx4 v71, s[26:27] nt
    s_mov_b32 m0, 111616
    v_add_u32 v71, 0x7000, v71
    s_waitcnt vmcnt(19)
    global_load_lds_dwordx4 v71, s[26:27] nt
    s_mov_b32 m0, 112640
    v_add_u32 v71, 0x7000, v71
    s_waitcnt vmcnt(19)
    global_load_lds_dwordx4 v71, s[26:27] nt
    s_mov_b32 m0, 113664
    v_add_u32 v71, 0x7000, v71
    s_waitcnt vmcnt(19)
    global_load_lds_dwordx4 v71, s[26:27] nt
    s_waitcnt vmcnt(8)
    v_mov_b32 v60, 5
    s_mov_b64 exec, 1
    ds_write_b32 v59, v60 offset:16
    s_mov_b64 exec, -1
    s_waitcnt vmcnt(0)
    v_mov_b32 v60, 6
    s_mov_b64 exec, 1
    ds_write_b32 v59, v60 offset:16
    s_mov_b64 exec, -1
    s_waitcnt lgkmcnt(0)
    s_barrier
    global_load_dword v61, v77, s[38:39] sc1
    s_add_u32 s9, s53, s15
    s_lshl_b32 s9, s9, 16
    s_add_u32 s9, s9, s14
    v_lshl_add_u32 v80, v67, 10, v68
    v_add_u32 v80, s9, v80
    v_xor_b32 v81, 64, v80
    s_mov_b32 m0, 114688
    s_nop 0
    global_load_lds_dwordx4 v80, s[32:33] nt
    s_mov_b32 m0, 116736
    v_add_u32 v81, 0x2000, v81
    global_load_lds_dwordx4 v81, s[32:33] nt
    s_mov_b32 m0, 118784
    v_add_u32 v80, 0x4000, v80
    global_load_lds_dwordx4 v80, s[32:33] nt
    s_mov_b32 m0, 120832
    v_add_u32 v81, 0x4000, v81
    global_load_lds_dwordx4 v81, s[32:33] nt
    s_mov_b32 m0, 115712
    v_add_u32 v80, 0x4000, v80
    global_load_lds_dwordx4 v80, s[32:33] nt
    s_mov_b32 m0, 117760
    v_add_u32 v81, 0x4000, v81
    global_load_lds_dwordx4 v81, s[32:33] nt
    s_mov_b32 m0, 119808
    v_add_u32 v80, 0x4000, v80
    global_load_lds_dwordx4 v80, s[32:33] nt
    s_mov_b32 m0, 121856
    v_add_u32 v81, 0x4000, v81
    global_load_lds_dwordx4 v81, s[32:33] nt
    s_waitcnt vmcnt(0) lgkmcnt(0)
    s_endpgm
L_codeend:
L_slow:
    s_nop 4
    buffer_store_dwordx2 v[120:121], v116, s[44:47], 0 offen sc1
    buffer_store_dwordx4 v[80:83], v5, s[44:47], 0 offen sc1
    buffer_store_dwordx4 v[124:127], v118, s[44:47], 0 offen sc1
    buffer_store_dwordx4 v[112:115], v60, s[44:47], 0 offen sc1
    v_add_u32 v10, 0x18000, v10
    v_add_u32 v12, 0x18000, v12
    buffer_store_dword v112, v10, s[44:47], 0 offen sc1
    buffer_store_dword v112, v10, s[44:47], s63 offen sc1
    v_pk_add_f32 v[72:73], v[144:145], v[148:149]
    v_pk_add_f32 v[74:75], v[146:147], v[150:151]
    s_nop 1
    v_permlane32_swap_b32 v72, v74
    v_permlane32_swap_b32 v73, v75
    v_add_f32 v76, v72, v74
    v_add_f32 v77, v73, v75
    v_fma_f32 v76, v76, v33, v31
    v_fma_f32 v77, v77, v33, v32
    v_cvt_pk_bf16_f32 v76, v76, v77
    ds_write_b32 v17, v76
    v_mov_b64 v[80:81], 0
    v_mov_b64 v[84:85], 0
    v_mov_b64 v[88:89], 0
    v_mov_b64 v[96:97], 0
    v_mov_b64 v[100:101], 0
    v_mov_b32 v120, 0
    v_mov_b32 v112, s51
    v_mov_b32 v113, s51
    v_mov_b32 v114, s51
    v_mov_b32 v115, s51
    v_mov_b32 v116, s51
    v_mov_b32 v117, s51
    v_mov_b32 v118, s51
    v_mov_b32 v119, s51
    v_mov_b32 v122, s6
    v_mov_b32 v123, s6
    v_mov_b32 v64, 1
    s_mov_b64 exec, 1
    ds_add_u32 v59, v64 offset:20
    s_mov_b64 exec, -1
S0_sq:
    s_mov_b64 exec, 1
    ds_read_b32 v64, v59 offset:20
    s_mov_b64 exec, -1
    s_sub_u32 s8, s8, 1
    s_cbranch_scc1 L_end
    s_waitcnt lgkmcnt(0)
    v_readfirstlane_b32 s9, v64
    s_cmp_lt_u32 s9, 4
    s_cbranch_scc1 S0_sq
    ds_read_b128 v[64:67], v18 offset:0
    ds_read_b128 v[68:71], v18 offset:64
    v_xor_b32 v79, 32, v45
    ds_read_b32 v123, v59 offset:28
    s_waitcnt lgkmcnt(0)
    s_waitcnt lgkmcnt(1)
    v_smfmac_f32_16x16x64_bf16 v[80:83], v[64:67], v[184:191], v52
    v_smfmac_f32_16x16x64_bf16 v[84:87], v[64:67], v[200:207], v52
    s_waitcnt lgkmcnt(0)
    v_smfmac_f32_16x16x64_bf16 v[80:83], v[68:71], v[192:199], v52
    v_smfmac_f32_16x16x64_bf16 v[84:87], v[68:71], v[208:215], v52
    s_nop 6
    v_add_f32 v72, v80, v81
    v_add_f32 v73, v84, v85
    v_exp_f32 v74, v72
    v_exp_f32 v75, v73
    v_max_f32 v76, |v72|, |v73|
    v_cvt_pk_bf16_f32 v74, v74, v75
    v_cmp_nge_f32 vcc, s65, v76
    ds_write_b32 v19, v74
    s_cbranch_vccnz S0_mx
S0_mxr:
    s_waitcnt vmcnt(0)
    v_mov_b32 v64, 1
    s_mov_b64 exec, 1
    ds_add_u32 v59, v64 offset:24
    s_mov_b64 exec, -1
S0_sp:
    s_mov_b64 exec, 1
    ds_read2_b32 v[64:65], v59 offset0:6 offset1:4
    s_mov_b64 exec, -1
    s_sub_u32 s8, s8, 1
    s_cbranch_scc1 L_end
    s_waitcnt lgkmcnt(0)
    v_readfirstlane_b32 s9, v64
    v_readfirstlane_b32 s10, v65
    s_cmp_lt_u32 s9, 4
    s_cbranch_scc1 S0_sp
    s_cmp_lt_u32 s10, 4
    s_cbranch_scc1 S0_sp
    ds_read_b128 v[64:67], v53 offset:0
    ds_read_b128 v[68:71], v53 offset:128
    ds_read_b128 v[72:75], v21 offset:0
    ds_read_b64_tr_b16 v[216:217], v45 offset:0
    ds_read_b64_tr_b16 v[218:219], v45 offset:512
    ds_read_b64_tr_b16 v[220:221], v45 offset:4096
    ds_read_b64_tr_b16 v[222:223], v45 offset:4608
    ds_read_b64_tr_b16 v[224:225], v79 offset:0
    ds_read_b64_tr_b16 v[226:227], v79 offset:512
    ds_read_b64_tr_b16 v[228:229], v79 offset:4096
    ds_read_b64_tr_b16 v[230:231], v79 offset:4608
    ds_read_b64_tr_b16 v[232:233], v45 offset:16384
    ds_read_b64_tr_b16 v[234:235], v45 offset:16896
    ds_read_b64_tr_b16 v[236:237], v45 offset:20480
    ds_read_b64_tr_b16 v[238:239], v45 offset:20992
    s_waitcnt lgkmcnt(12)
    v_smfmac_f32_16x16x64_bf16 v[88:91], v[64:67], v[112:119], v52
    v_or3_b32 v78, v72, v73, v74
    v_smfmac_f32_16x16x64_bf16 v[88:91], v[68:71], v[112:119], v52
    v_or_b32 v78, v78, v75
    s_waitcnt lgkmcnt(8)
    ds_read_b64_tr_b16 v[240:241], v79 offset:16384
    ds_read_b64_tr_b16 v[242:243], v79 offset:16896
    ds_read_b64_tr_b16 v[244:245], v79 offset:20480
    ds_read_b64_tr_b16 v[246:247], v79 offset:20992
    v_smfmac_f32_16x16x64_bf16 v[96:99], v[64:67], v[216:223], v52
    v_cmp_ne_u32 vcc, 0, v78
    s_waitcnt lgkmcnt(8)
    v_smfmac_f32_16x16x64_bf16 v[100:103], v[64:67], v[224:231], v52
    s_waitcnt lgkmcnt(4)
    v_smfmac_f32_16x16x64_bf16 v[96:99], v[68:71], v[232:239], v52
    s_waitcnt lgkmcnt(0)
    v_smfmac_f32_16x16x64_bf16 v[100:103], v[68:71], v[240:247], v52
    v_add_f32 v121, v88, v89
    s_cbranch_vccnz S0_pv
    buffer_store_dwordx4 v[120:123], v9, s[44:47], 0 offen sc1
    s_nop 2
    v_add_f32 v76, v96, v97
    s_nop 0
    v_add_f32 v77, v100, v101
S0_pvr:
    v_cvt_pk_bf16_f32 v76, v76, v77
    v_min_u32 v76, -2, v76
    buffer_store_dword v76, v10, s[44:47], s63 offen sc1
    v_mov_b64 v[92:93], -1
    buffer_store_dwordx2 v[92:93], v14, s[40:43], 0 offen sc1
S0_so:
    s_mov_b64 exec, 1
    ds_read_b32 v64, v59 offset:16
    s_mov_b64 exec, -1
    s_sub_u32 s8, s8, 1
    s_cbranch_scc1 L_end
    s_waitcnt lgkmcnt(0)
    v_readfirstlane_b32 s9, v64
    s_cmp_lt_u32 s9, 5
    s_cbranch_scc1 S0_so
S0_s3m:
    buffer_load_dwordx4 v[64:67], v11, s[44:47], 0 offen sc1
    s_sub_u32 s8, s8, 1
    s_cbranch_scc1 L_end
    s_waitcnt vmcnt(0)
    v_cmp_ne_u32 vcc, s6, v66
    s_cbranch_vccnz S0_s3m
    buffer_load_dwordx4 v[68:71], v12, s[44:47], s63 offen sc1
    buffer_load_dwordx4 v[72:75], v12, s[44:47], s63 offen offset:1024 sc1
    v_max_f32_dpp v84, v64, v64 quad_perm:[1,0,3,2] row_mask:0xf bank_mask:0xf
    s_nop 1
    v_max_f32_dpp v84, v84, v84 quad_perm:[2,3,0,1] row_mask:0xf bank_mask:0xf
    s_nop 1
    v_max_f32_dpp v84, v84, v84 row_half_mirror row_mask:0xf bank_mask:0xf
    v_sub_f32 v84, v64, v84
    v_exp_f32 v84, v84
    s_nop 0
    v_cvt_pk_bf16_f32 v84, v84, v84
    v_and_b32 v85, 0xffff0000, v84
    s_nop 0
    v_and_b32_dpp v88, v84, v48 row_newbcast:0 row_mask:0xf bank_mask:0xf
    v_and_b32_dpp v89, v84, v49 row_newbcast:0 row_mask:0xf bank_mask:0xf
    v_and_b32_dpp v90, v84, v50 row_newbcast:0 row_mask:0xf bank_mask:0xf
    v_and_b32_dpp v91, v84, v51 row_newbcast:0 row_mask:0xf bank_mask:0xf
    v_mul_f32 v85, v85, v65
    v_and_b32_dpp v92, v84, v48 row_newbcast:4 row_mask:0xf bank_mask:0xf
    v_and_b32_dpp v93, v84, v49 row_newbcast:4 row_mask:0xf bank_mask:0xf
    v_add_f32_dpp v85, v85, v85 quad_perm:[1,0,3,2] row_mask:0xf bank_mask:0xf
    v_and_b32_dpp v94, v84, v50 row_newbcast:4 row_mask:0xf bank_mask:0xf
    v_and_b32_dpp v95, v84, v51 row_newbcast:4 row_mask:0xf bank_mask:0xf
    v_add_f32_dpp v85, v85, v85 quad_perm:[2,3,0,1] row_mask:0xf bank_mask:0xf
    v_mov_b32 v87, v85
    v_mov_b32 v127, v67
    s_branch S0_s3w
S0_s3poll:
    buffer_load_dwordx4 v[68:71], v12, s[44:47], s63 offen sc1
    buffer_load_dwordx4 v[72:75], v12, s[44:47], s63 offen offset:1024 sc1
    s_sub_u32 s8, s8, 1
    s_cbranch_scc1 L_end
    v_mov_b32 v85, v87
S0_s3w:
    s_waitcnt vmcnt(1)
    v_mfma_f32_16x16x32_bf16 v[80:83], v[88:91], v[68:71], 0
    v_add_f32_dpp v85, v85, v85 row_half_mirror row_mask:0xf bank_mask:0xf
    v_max3_u32 v86, v68, v69, v70
    s_waitcnt vmcnt(0)
    v_mfma_f32_16x16x32_bf16 v[80:83], v[92:95], v[72:75], v[80:83]
    v_rcp_f32 v85, v85
    v_max3_u32 v76, v71, v72, v73
    v_max3_u32 v86, v86, v74, v75
    v_max_u32 v86, v86, v76
    v_cmp_eq_u32 vcc, -1, v86
    s_nop 2
    v_mul_f32 v80, v80, v85
    v_mul_f32 v81, v81, v85
    v_cvt_pk_bf16_f32 v80, v80, v81
    ds_write_b32 v54, v80
    s_cbranch_vccnz S0_s3poll
    s_waitcnt lgkmcnt(0)
    s_barrier
    ds_read_b128 v[64:67], v22 offset:0
    ds_read_b64_tr_b16 v[160:161], v57 offset:0
    ds_read_b64_tr_b16 v[162:163], v57 offset:256
    ds_read_b128 v[68:71], v22 offset:64
    ds_read_b64_tr_b16 v[164:165], v57 offset:1024
    ds_read_b64_tr_b16 v[166:167], v57 offset:1280
    ds_read_b128 v[72:75], v22 offset:128
    ds_read_b64_tr_b16 v[168:169], v57 offset:2048
    ds_read_b64_tr_b16 v[170:171], v57 offset:2304
    ds_read_b128 v[76:79], v22 offset:192
    ds_read_b64_tr_b16 v[172:173], v57 offset:3072
    ds_read_b64_tr_b16 v[174:175], v57 offset:3328
    s_mov_b32 s56, 0x180000
    v_xor_b32 v86, s62, v13
    v_xor_b32 v87, s62, v16
    s_waitcnt lgkmcnt(9)
    v_mfma_f32_16x16x32_bf16 v[80:83], v[64:67], v[160:163], 0
    s_waitcnt lgkmcnt(6)
    v_mfma_f32_16x16x32_bf16 v[80:83], v[68:71], v[164:167], v[80:83]
    s_waitcnt lgkmcnt(3)
    v_mfma_f32_16x16x32_bf16 v[80:83], v[72:75], v[168:171], v[80:83]
    s_waitcnt lgkmcnt(0)
    v_mfma_f32_16x16x32_bf16 v[80:83], v[76:79], v[172:175], v[80:83]
    s_nop 7
    v_cvt_pk_bf16_f32 v84, v80, v81
    v_cvt_pk_bf16_f32 v85, v82, v83
    v_bfi_b32 v84, s55, v86, v84
    v_bfi_b32 v85, s55, v87, v85
    buffer_store_dwordx2 v[84:85], v252, s[40:43], s56 offen sc1
    v_mov_b64 v[92:93], -1
    s_mov_b32 s9, 0x80000
    s_mov_b32 s10, 0x100000
    buffer_store_dwordx2 v[92:93], v252, s[40:43], s9 offen sc1
    buffer_store_dwordx2 v[92:93], v14, s[40:43], s10 offen sc1
    v_add_u32_dpp v88, v127, v127 quad_perm:[1,0,3,2] row_mask:0xf bank_mask:0xf
    s_nop 1
    v_add_u32_dpp v88, v88, v88 quad_perm:[2,3,0,1] row_mask:0xf bank_mask:0xf
    s_nop 1
    v_add_u32_dpp v88, v88, v88 row_half_mirror row_mask:0xf bank_mask:0xf
    s_nop 0
    v_readfirstlane_b32 s9, v88
    s_cmp_gt_i32 s9, 0
    s_cselect_b32 s11, 0x2000, 0
    v_add_u32 v253, s11, v253
    ds_read_b32 v64, v59 offset:16
    s_waitcnt lgkmcnt(0)
    v_readfirstlane_b32 s48, v64
    s_cmp_lt_u32 s48, 6
    s_cbranch_scc1 S0_n13
    ds_read_b64_tr_b16 v[144:145], v56 offset:32768
    ds_read_b64_tr_b16 v[146:147], v56 offset:33280
    ds_read_b64_tr_b16 v[148:149], v56 offset:33792
    ds_read_b64_tr_b16 v[150:151], v56 offset:34304
    ds_read_b64_tr_b16 v[152:153], v56 offset:34816
    ds_read_b64_tr_b16 v[154:155], v56 offset:35328
    ds_read_b64_tr_b16 v[156:157], v56 offset:35840
    ds_read_b64_tr_b16 v[158:159], v56 offset:36352
    v_mov_b32 v100, s51
    v_mov_b32 v101, s51
    v_mov_b32 v102, s51
    v_mov_b32 v103, s51
    s_waitcnt lgkmcnt(0)
    s_nop 0
    v_mfma_f32_16x16x32_bf16 v[96:99], v[144:147], v[100:103], 0
    v_mfma_f32_16x16x32_bf16 v[96:99], v[148:151], v[100:103], v[96:99]
    v_mfma_f32_16x16x32_bf16 v[96:99], v[152:155], v[100:103], v[96:99]
    v_mfma_f32_16x16x32_bf16 v[96:99], v[156:159], v[100:103], v[96:99]
    s_nop 7
    v_bfi_b32 v96, s12, v25, v96
    v_bfi_b32 v97, s12, v25, v97
    v_bfi_b32 v98, s12, v25, v98
    v_bfi_b32 v99, s12, v25, v99
    buffer_store_dwordx4 v[96:99], v46, s[44:47], 0 offen sc1
S0_n13:
    s_mov_b32 s58, 0xb000
    s_cmp_lg_u32 s5, 0
    s_cbranch_scc1 S0_s4_oth
    s_and_b32 s56, s50, 1
    s_lshl_b32 s56, s56, 14
    s_add_u32 s56, s56, 0x180000
    s_sleep 8
S0_s4:
    buffer_load_dwordx4 v[64:67], v253, s[40:43], s56 offen offset:0 sc1
    buffer_load_dwordx4 v[68:71], v253, s[40:43], s56 offen offset:1024 sc1
    buffer_load_dwordx4 v[72:75], v253, s[40:43], s56 offen offset:2048 sc1
    buffer_load_dwordx4 v[76:79], v253, s[40:43], s56 offen offset:3072 sc1
    s_sub_u32 s8, s8, 1
    s_cbranch_scc1 L_end
    s_waitcnt vmcnt(3)
    v_mfma_f32_16x16x32_bf16 v[80:83], v[248:251], v[64:67], 0
    v_bitop3_b32 v84, v64, v66, v47 bitop3:0x7e
    v_bitop3_b32 v85, v65, v67, v15 bitop3:0x7e
    s_waitcnt vmcnt(2)
    v_mfma_f32_16x16x32_bf16 v[80:83], v[248:251], v[68:71], v[80:83]
    v_bitop3_b32 v86, v68, v70, v47 bitop3:0x7e
    v_bitop3_b32 v87, v69, v71, v15 bitop3:0x7e
    v_or3_b32 v84, v84, v85, v86
    s_waitcnt vmcnt(1)
    v_mfma_f32_16x16x32_bf16 v[80:83], v[248:251], v[72:75], v[80:83]
    v_bitop3_b32 v88, v72, v74, v47 bitop3:0x7e
    v_bitop3_b32 v89, v73, v75, v15 bitop3:0x7e
    v_or3_b32 v84, v84, v87, v88
    s_waitcnt vmcnt(0)
    v_mfma_f32_16x16x32_bf16 v[80:83], v[248:251], v[76:79], v[80:83]
    v_bitop3_b32 v90, v76, v78, v47 bitop3:0x7e
    v_bitop3_b32 v91, v77, v79, v15 bitop3:0x7e
    v_or3_b32 v89, v89, v90, v91
    v_bitop3_b32 v84, v84, v89, s55 bitop3:0xa8
    v_cmp_ne_u32 vcc, 0, v84
    s_nop 2
    v_add_f32_dpp v80, v80, v80 row_ror:8 row_mask:0xf bank_mask:0xf
    v_add_f32_dpp v81, v81, v81 row_ror:8 row_mask:0xf bank_mask:0xf
    s_cbranch_vccnz S0_s4
    v_cvt_pk_bf16_f32 v80, v80, v81
    v_and_b32 v81, 0xffff0000, v80
    v_lshlrev_b32 v80, 16, v80
    v_add_f32 v81, v81, v30
    v_add_f32 v80, v80, v255
    v_cvt_pk_bf16_f32 v80, v80, v81
    v_min_u32 v81, -2, v80
    buffer_store_dword v81, v254, s[44:47], s58 offen sc1
    v_lshlrev_b32 v255, 16, v80
    v_and_b32 v30, 0xffff0000, v80
S0_s4_oth:
    s_cmp_lt_u32 s48, 6
    s_cbranch_scc1 S0_l13
S0_l13r:
    s_nop 15
    s_barrier
    ds_read_b64_tr_b16 v[176:177], v58 offset:0
    ds_read_b64_tr_b16 v[178:179], v58 offset:512
    ds_read_b64_tr_b16 v[180:181], v58 offset:1024
    ds_read_b64_tr_b16 v[182:183], v58 offset:1536
    s_sub_u32 s56, 4, s5
    s_lshl_b32 s56, s56, 10
    buffer_load_dwordx4 v[34:37], v2, s[44:47], s58 offen sc1
    s_nop 15
    buffer_load_dwordx4 v[34:37], v2, s[44:47], s58 offen sc1
    s_nop 15
S0_s5:
    buffer_load_dwordx4 v[34:37], v2, s[44:47], s58 offen sc1
    s_sub_u32 s8, s8, 1
    s_cbranch_scc1 L_end
    s_waitcnt vmcnt(2)
    v_max3_u32 v72, v34, v35, v36
    v_max_u32 v72, v72, v37
    v_mfma_f32_16x16x32_bf16 v[80:83], v[144:147], v[34:37], 0
    v_cmp_eq_u32 vcc, -1, v72
    v_mfma_f32_16x16x32_bf16 v[84:87], v[148:151], v[34:37], 0
    v_mfma_f32_16x16x32_bf16 v[88:91], v[152:155], v[34:37], 0
    s_cbranch_vccnz S0_s5
    v_mfma_f32_16x16x32_bf16 v[92:95], v[156:159], v[34:37], 0
    buffer_load_dwordx4 v[74:77], v4, s[44:47], s58 offen sc1
    buffer_load_dwordx4 v[104:107], v8, s[44:47], s56 offen sc1
    buffer_load_dwordx4 v[108:111], v8, s[44:47], s56 offen offset:256 sc1
    s_nop 1
    v_add_f32_dpp v80, v84, v80 quad_perm:[1,1,1,1] row_mask:0xf bank_mask:0xf
    v_add_f32_dpp v81, v85, v81 quad_perm:[1,1,1,1] row_mask:0xf bank_mask:0xf
    v_add_f32_dpp v82, v86, v82 quad_perm:[1,1,1,1] row_mask:0xf bank_mask:0xf
    v_add_f32_dpp v83, v87, v83 quad_perm:[1,1,1,1] row_mask:0xf bank_mask:0xf
    v_add_f32_dpp v80, v88, v80 quad_perm:[2,2,2,2] row_mask:0xf bank_mask:0xf
    v_add_f32_dpp v81, v89, v81 quad_perm:[2,2,2,2] row_mask:0xf bank_mask:0xf
    v_add_f32_dpp v82, v90, v82 quad_perm:[2,2,2,2] row_mask:0xf bank_mask:0xf
    v_add_f32_dpp v83, v91, v83 quad_perm:[2,2,2,2] row_mask:0xf bank_mask:0xf
    v_add_f32_dpp v80, v92, v80 quad_perm:[3,3,3,3] row_mask:0xf bank_mask:0xf
    v_add_f32_dpp v81, v93, v81 quad_perm:[3,3,3,3] row_mask:0xf bank_mask:0xf
    v_add_f32_dpp v82, v94, v82 quad_perm:[3,3,3,3] row_mask:0xf bank_mask:0xf
    v_add_f32_dpp v83, v95, v83 quad_perm:[3,3,3,3] row_mask:0xf bank_mask:0xf
    v_bfi_b32 v80, s12, v25, v80
    v_bfi_b32 v81, s12, v25, v81
    v_bfi_b32 v82, s12, v25, v82
    v_bfi_b32 v83, s12, v25, v83
    buffer_store_dwordx4 v[80:83], v6, s[44:47], 0 offen sc1
    s_waitcnt vmcnt(1)
    s_branch S0_s6st_c
S0_s6st:
    buffer_load_dwordx4 v[74:77], v4, s[44:47], s58 offen sc1
    buffer_load_dwordx4 v[104:107], v8, s[44:47], s56 offen sc1
    buffer_load_dwordx4 v[108:111], v8, s[44:47], s56 offen offset:256 sc1
    s_sub_u32 s8, s8, 1
    s_cbranch_scc1 L_end
    s_waitcnt vmcnt(0)
S0_s6st_c:
    v_max3_u32 v96, v74, v75, v76
    v_max_u32 v96, v96, v77
    v_cmp_eq_u32 vcc, -1, v96
    s_cbranch_vccnz S0_s6st
    v_bitop3_b32 v120, v104, v105, s6 bitop3:0x7e
    v_bitop3_b32 v121, v106, v107, s6 bitop3:0x7e
    v_bitop3_b32 v122, v108, v109, s6 bitop3:0x7e
    v_bitop3_b32 v123, v110, v111, s6 bitop3:0x7e
    v_or3_b32 v120, v120, v121, v122
    v_bitop3_b32 v123, v123, v120, s12 bitop3:0xa8
    v_cmp_ne_u32 vcc, 0, v123
    s_cbranch_vccnz S0_s6st
    s_cmp_lg_u32 s49, 0
    s_cbranch_scc1 S0_w2ok
    s_waitcnt lgkmcnt(0)
    v_mov_b32 v176, 0
    v_mov_b32 v177, 0
    v_mov_b32 v178, 0
    v_mov_b32 v179, 0
    v_mov_b32 v180, 0
    v_mov_b32 v181, 0
    v_mov_b32 v182, 0
    v_mov_b32 v183, 0
S0_w2ok:
    buffer_load_dwordx4 v[38:41], v8, s[44:47], 0 offen sc1
    buffer_load_dwordx4 v[42:45], v8, s[44:47], 0 offen offset:256 sc1
    v_pk_add_f32 v[104:105], v[104:105], v[108:109]
    v_pk_add_f32 v[106:107], v[106:107], v[110:111]
    s_nop 1
    v_permlane16_swap_b32 v104, v106
    v_permlane16_swap_b32 v105, v107
    v_add_f32 v28, v104, v106
    v_add_f32 v29, v105, v107
    s_nop 1
    v_permlane32_swap_b32 v28, v29
    v_dot2_f32_bf16 v96, v74, s51, 0
    v_dot2_f32_bf16 v97, v74, v74, 0
    v_dot2_f32_bf16 v96, v75, s51, v96
    v_dot2_f32_bf16 v97, v75, v75, v97
    v_dot2_f32_bf16 v96, v76, s51, v96
    v_dot2_f32_bf16 v97, v76, v76, v97
    v_dot2_f32_bf16 v96, v77, s51, v96
    v_dot2_f32_bf16 v97, v77, v77, v97
    v_mov_b32 v98, 0x3b000000
    s_nop 0
    v_add_f32_dpp v96, v96, v96 quad_perm:[1,0,3,2] row_mask:0xf bank_mask:0xf
    v_add_f32_dpp v97, v97, v97 quad_perm:[1,0,3,2] row_mask:0xf bank_mask:0xf
    s_nop 0
    v_add_f32_dpp v96, v96, v96 quad_perm:[2,3,0,1] row_mask:0xf bank_mask:0xf
    v_add_f32_dpp v97, v97, v97 quad_perm:[2,3,0,1] row_mask:0xf bank_mask:0xf
    s_nop 0
    v_add_f32_dpp v96, v96, v96 row_half_mirror row_mask:0xf bank_mask:0xf
    v_add_f32_dpp v97, v97, v97 row_half_mirror row_mask:0xf bank_mask:0xf
    s_nop 0
    v_add_f32_dpp v96, v96, v96 row_mirror row_mask:0xf bank_mask:0xf
    v_add_f32_dpp v97, v97, v97 row_mirror row_mask:0xf bank_mask:0xf
    s_nop 0
    v_add_f32_dpp v96, v96, v96 row_bcast:15 row_mask:0xa bank_mask:0xf
    v_add_f32_dpp v97, v97, v97 row_bcast:15 row_mask:0xa bank_mask:0xf
    s_nop 0
    v_add_f32_dpp v96, v96, v96 row_bcast:31 row_mask:0xc bank_mask:0xf
    v_add_f32_dpp v97, v97, v97 row_bcast:31 row_mask:0xc bank_mask:0xf
    v_readlane_b32 s9, v96, 63
    v_readlane_b32 s10, v97, 63
    s_nop 0
    v_mul_f32 v96, s9, v98
    v_mul_f32 v97, s10, v98
    v_fma_f32 v97, -v96, v96, v97
    v_max_f32 v97, 0, v97
    v_add_f32 v97, 0x3727c5ac, v97
    v_rsq_f32 v33, v97
    s_nop 0
    v_mul_f32 v78, -v96, v33
    v_mul_f32 v31, v78, v28
    v_mul_f32 v32, v78, v29
    v_mul_f32 v94, 0xbfb8aa3b, v33
    v_mul_f32 v95, 0xbfb8aa3b, v31
    s_mov_b32 s56, 0x0
    s_mov_b64 vcc, -1
S0_s6poll:
    s_mov_b64 exec, vcc
    buffer_load_dwordx4 v[38:41], v8, s[44:47], 0 offen sc1
    buffer_load_dwordx4 v[42:45], v8, s[44:47], 0 offen offset:256 sc1
    s_mov_b64 exec, -1
    s_sub_u32 s8, s8, 1
    s_cbranch_scc1 L_end
    s_waitcnt vmcnt(2)
    v_bitop3_b32 v80, v38, v39, s6 bitop3:0x7e
    v_bitop3_b32 v81, v40, v41, s6 bitop3:0x7e
    v_bitop3_b32 v82, v42, v43, s6 bitop3:0x7e
    v_bitop3_b32 v83, v44, v45, s6 bitop3:0x7e
    v_pk_add_f32 v[72:73], v[38:39], v[42:43]
    v_pk_add_f32 v[74:75], v[40:41], v[44:45]
    v_or3_b32 v80, v80, v81, v82
    v_bitop3_b32 v80, v80, v83, s12 bitop3:0xa8
    v_permlane16_swap_b32 v72, v74
    v_permlane16_swap_b32 v73, v75
    v_cmp_ne_u32 vcc, 0, v80
    v_add_f32 v72, v72, v74
    v_add_f32 v74, v73, v75
    s_nop 1
    v_permlane32_swap_b32 v72, v74
    v_fma_f32 v73, v72, v94, v95
    s_cbranch_vccnz S0_s6poll
    v_exp_f32 v73, v73
    v_fma_f32 v72, v72, v33, v31
    v_add_f32 v73, 1.0, v73
    v_fma_f32 v74, v74, v33, v32
    v_rcp_f32 v73, v73
    v_mul_f32 v74, v74, v72
    v_mul_f32 v72, v74, v73
    v_cvt_pk_bf16_f32 v72, v72, v72
    ds_write_b16 v23, v72
    s_waitcnt lgkmcnt(0)
    s_barrier
    ds_read_b128 v[64:67], v24 offset:0
    ds_read_b128 v[68:71], v24 offset:64
    s_waitcnt lgkmcnt(1)
    v_mfma_f32_16x16x32_bf16 v[80:83], v[64:67], v[176:179], 0
    s_waitcnt lgkmcnt(0)
    v_mfma_f32_16x16x32_bf16 v[80:83], v[68:71], v[180:183], v[80:83]
    s_nop 7
    v_cvt_pk_bf16_f32 v84, v80, v81
    v_cvt_pk_bf16_f32 v85, v82, v83
    v_min_u32 v84, -2, v84
    v_min_u32 v85, -2, v85
    buffer_store_dwordx2 v[84:85], v14, s[40:43], s56 offen sc1
    s_sub_u32 s57, 4, s15
    s_lshl_b32 s57, s57, 13
    buffer_load_dwordx4 v[104:107], v7, s[44:47], s57 offen sc1
    buffer_load_dwordx4 v[108:111], v7, s[44:47], s57 offen offset:2048 sc1
    s_mov_b32 s58, 0xc000
    s_cmp_lg_u32 s5, 0
    s_cbranch_scc1 S0_s7_oth
    s_and_b32 s56, s50, 1
    s_lshl_b32 s56, s56, 14
    s_add_u32 s56, s56, 0x0
    s_sleep 8
S0_s7:
    buffer_load_dwordx4 v[64:67], v253, s[40:43], s56 offen offset:0 sc1
    buffer_load_dwordx4 v[68:71], v253, s[40:43], s56 offen offset:1024 sc1
    buffer_load_dwordx4 v[72:75], v253, s[40:43], s56 offen offset:2048 sc1
    buffer_load_dwordx4 v[76:79], v253, s[40:43], s56 offen offset:3072 sc1
    s_sub_u32 s8, s8, 1
    s_cbranch_scc1 L_end
    s_waitcnt vmcnt(3)
    v_mfma_f32_16x16x32_bf16 v[80:83], v[248:251], v[64:67], 0
    v_max3_u32 v84, v64, v65, v66
    v_mov_b32 v85, v67
    s_waitcnt vmcnt(2)
    v_mfma_f32_16x16x32_bf16 v[80:83], v[248:251], v[68:71], v[80:83]
    v_max3_u32 v84, v84, v68, v69
    v_max3_u32 v85, v85, v70, v71
    s_waitcnt vmcnt(1)
    v_mfma_f32_16x16x32_bf16 v[80:83], v[248:251], v[72:75], v[80:83]
    v_max3_u32 v84, v84, v72, v73
    v_max3_u32 v85, v85, v74, v75
    s_waitcnt vmcnt(0)
    v_mfma_f32_16x16x32_bf16 v[80:83], v[248:251], v[76:79], v[80:83]
    v_max3_u32 v84, v84, v76, v77
    v_max3_u32 v85, v85, v78, v79
    v_max_u32 v84, v84, v85
    v_cmp_eq_u32 vcc, -1, v84
    s_nop 3
    v_add_f32_dpp v80, v80, v80 row_ror:8 row_mask:0xf bank_mask:0xf
    v_add_f32_dpp v81, v81, v81 row_ror:8 row_mask:0xf bank_mask:0xf
    s_cbranch_vccnz S0_s7
    v_cvt_pk_bf16_f32 v80, v80, v81
    v_and_b32 v81, 0xffff0000, v80
    v_lshlrev_b32 v80, 16, v80
    v_add_f32 v81, v81, v30
    v_add_f32 v80, v80, v255
    v_cvt_pk_bf16_f32 v80, v80, v81
    v_min_u32 v81, -2, v80
    buffer_store_dword v81, v254, s[44:47], s58 offen sc1
    v_lshlrev_b32 v255, 16, v80
    v_and_b32 v30, 0xffff0000, v80
S0_s7_oth:
    s_cmp_eq_u32 s5, 0
    s_cbranch_scc1 S0_qcc
S0_qcw:
    s_waitcnt vmcnt(0)
S0_qcc:
    v_bitop3_b32 v92, v104, v105, s6 bitop3:0x7e
    v_bitop3_b32 v93, v106, v107, s6 bitop3:0x7e
    v_bitop3_b32 v94, v108, v109, s6 bitop3:0x7e
    v_bitop3_b32 v95, v110, v111, s6 bitop3:0x7e
    v_or3_b32 v92, v92, v93, v94
    v_bitop3_b32 v95, v95, v92, s12 bitop3:0xa8
    v_cmp_ne_u32 vcc, 0, v95
    v_pk_add_f32 v[96:97], v[104:105], v[108:109]
    v_pk_add_f32 v[98:99], v[106:107], v[110:111]
    s_nop 1
    v_permlane32_swap_b32 v96, v98
    v_permlane32_swap_b32 v97, v99
    v_add_f32 v26, v96, v98
    v_add_f32 v27, v97, v99
    s_cbranch_vccnz S0_qcr
    s_add_u32 s6, s6, 1
    v_mov_b32 v25, s6
    s_barrier
    buffer_load_dwordx4 v[34:37], v2, s[44:47], s58 offen sc1
    s_nop 15
    buffer_load_dwordx4 v[34:37], v2, s[44:47], s58 offen sc1
    s_nop 15
S1_s1:
    buffer_load_dwordx4 v[34:37], v2, s[44:47], s58 offen sc1
    s_sub_u32 s8, s8, 1
    s_cbranch_scc1 L_end
    s_waitcnt vmcnt(2)
    v_max3_u32 v72, v34, v35, v36
    v_max_u32 v72, v72, v37
    v_mfma_f32_16x16x32_bf16 v[80:83], v[128:131], v[34:37], 0
    v_cmp_eq_u32 vcc, -1, v72
    v_mfma_f32_16x16x32_bf16 v[84:87], v[132:135], v[34:37], 0
    v_mfma_f32_16x16x32_bf16 v[88:91], v[136:139], v[34:37], 0
    s_cbranch_vccnz S1_s1
    v_mfma_f32_16x16x32_bf16 v[92:95], v[140:143], v[34:37], 0
    buffer_load_dwordx4 v[74:77], v3, s[44:47], s58 offen sc1
    s_nop 3
    v_add_f32_dpp v80, v84, v80 quad_perm:[1,1,1,1] row_mask:0xf bank_mask:0xf
    v_add_f32_dpp v81, v85, v81 quad_perm:[1,1,1,1] row_mask:0xf bank_mask:0xf
    v_add_f32_dpp v82, v86, v82 quad_perm:[1,1,1,1] row_mask:0xf bank_mask:0xf
    v_add_f32_dpp v83, v87, v83 quad_perm:[1,1,1,1] row_mask:0xf bank_mask:0xf
    v_add_f32_dpp v80, v88, v80 quad_perm:[2,2,2,2] row_mask:0xf bank_mask:0xf
    v_add_f32_dpp v81, v89, v81 quad_perm:[2,2,2,2] row_mask:0xf bank_mask:0xf
    v_add_f32_dpp v82, v90, v82 quad_perm:[2,2,2,2] row_mask:0xf bank_mask:0xf
    v_add_f32_dpp v83, v91, v83 quad_perm:[2,2,2,2] row_mask:0xf bank_mask:0xf
    v_add_f32_dpp v80, v92, v80 quad_perm:[3,3,3,3] row_mask:0xf bank_mask:0xf
    v_add_f32_dpp v81, v93, v81 quad_perm:[3,3,3,3] row_mask:0xf bank_mask:0xf
    v_add_f32_dpp v82, v94, v82 quad_perm:[3,3,3,3] row_mask:0xf bank_mask:0xf
    v_add_f32_dpp v83, v95, v83 quad_perm:[3,3,3,3] row_mask:0xf bank_mask:0xf
    v_bfi_b32 v80, s12, v25, v80
    v_bfi_b32 v81, s12, v25, v81
    v_bfi_b32 v82, s12, v25, v82
    v_bfi_b32 v83, s12, v25, v83
    buffer_store_dwordx4 v[80:83], v5, s[44:47], 0 offen sc1
    s_waitcnt vmcnt(1)
    s_branch S1_s2st_c
S1_s2st:
    buffer_load_dwordx4 v[74:77], v3, s[44:47], s58 offen sc1
    s_sub_u32 s8, s8, 1
    s_cbranch_scc1 L_end
    s_waitcnt vmcnt(0)
S1_s2st_c:
    v_max3_u32 v96, v74, v75, v76
    v_max_u32 v96, v96, v77
    v_cmp_eq_u32 vcc, -1, v96
    s_cbranch_vccnz S1_s2st
    v_mov_b64 v[80:81], 0
    v_mov_b64 v[84:85], 0
    v_mov_b64 v[88:89], 0
    v_mov_b64 v[96:97], 0
    v_mov_b64 v[100:101], 0
    v_mov_b32 v120, 0
    v_mov_b32 v112, s51
    v_mov_b32 v113, s51
    v_mov_b32 v114, s51
    v_mov_b32 v115, s51
    v_mov_b32 v116, s51
    v_mov_b32 v117, s51
    v_mov_b32 v118, s51
    v_mov_b32 v119, s51
    v_mov_b32 v122, s6
    v_mov_b32 v123, s6
    buffer_load_dwordx4 v[38:41], v7, s[44:47], 0 offen sc1
    buffer_load_dwordx4 v[42:45], v7, s[44:47], 0 offen offset:2048 sc1
    v_dot2_f32_bf16 v96, v74, s51, 0
    v_dot2_f32_bf16 v97, v74, v74, 0
    v_dot2_f32_bf16 v96, v75, s51, v96
    v_dot2_f32_bf16 v97, v75, v75, v97
    v_dot2_f32_bf16 v96, v76, s51, v96
    v_dot2_f32_bf16 v97, v76, v76, v97
    v_dot2_f32_bf16 v96, v77, s51, v96
    v_dot2_f32_bf16 v97, v77, v77, v97
    v_mov_b32 v98, 0x3b000000
    s_nop 0
    v_add_f32_dpp v96, v96, v96 quad_perm:[1,0,3,2] row_mask:0xf bank_mask:0xf
    v_add_f32_dpp v97, v97, v97 quad_perm:[1,0,3,2] row_mask:0xf bank_mask:0xf
    s_nop 0
    v_add_f32_dpp v96, v96, v96 quad_perm:[2,3,0,1] row_mask:0xf bank_mask:0xf
    v_add_f32_dpp v97, v97, v97 quad_perm:[2,3,0,1] row_mask:0xf bank_mask:0xf
    s_nop 0
    v_add_f32_dpp v96, v96, v96 row_half_mirror row_mask:0xf bank_mask:0xf
    v_add_f32_dpp v97, v97, v97 row_half_mirror row_mask:0xf bank_mask:0xf
    s_nop 0
    v_add_f32_dpp v96, v96, v96 row_mirror row_mask:0xf bank_mask:0xf
    v_add_f32_dpp v97, v97, v97 row_mirror row_mask:0xf bank_mask:0xf
    s_nop 0
    v_add_f32_dpp v96, v96, v96 row_bcast:15 row_mask:0xa bank_mask:0xf
    v_add_f32_dpp v97, v97, v97 row_bcast:15 row_mask:0xa bank_mask:0xf
    s_nop 0
    v_add_f32_dpp v96, v96, v96 row_bcast:31 row_mask:0xc bank_mask:0xf
    v_add_f32_dpp v97, v97, v97 row_bcast:31 row_mask:0xc bank_mask:0xf
    v_readlane_b32 s9, v96, 63
    v_readlane_b32 s10, v97, 63
    s_nop 0
    v_mul_f32 v96, s9, v98
    v_mul_f32 v97, s10, v98
    v_fma_f32 v97, -v96, v96, v97
    v_max_f32 v97, 0, v97
    v_add_f32 v97, 0x3727c5ac, v97
    v_rsq_f32 v33, v97
    s_nop 0
    v_mul_f32 v33, 0x3e0293ee, v33
    v_mul_f32 v78, -v96, v33
    v_mul_f32 v31, v78, v26
    v_mul_f32 v32, v78, v27
    v_mov_b64 v[96:97], 0
    s_mov_b64 vcc, -1
S1_s2poll:
    s_mov_b64 exec, vcc
    buffer_load_dwordx4 v[38:41], v7, s[44:47], 0 offen sc1
    buffer_load_dwordx4 v[42:45], v7, s[44:47], 0 offen offset:2048 sc1
    s_mov_b64 exec, -1
    s_sub_u32 s8, s8, 1
    s_cbranch_scc1 L_end
    s_waitcnt vmcnt(2)
    v_bitop3_b32 v124, v38, v39, s6 bitop3:0x7e
    v_bitop3_b32 v125, v40, v41, s6 bitop3:0x7e
    v_bitop3_b32 v126, v42, v43, s6 bitop3:0x7e
    v_bitop3_b32 v127, v44, v45, s6 bitop3:0x7e
    v_pk_add_f32 v[72:73], v[38:39], v[42:43]
    v_pk_add_f32 v[74:75], v[40:41], v[44:45]
    v_or3_b32 v124, v124, v125, v126
    v_bitop3_b32 v124, v124, v127, s12 bitop3:0xa8
    v_permlane32_swap_b32 v72, v74
    v_permlane32_swap_b32 v73, v75
    v_cmp_ne_u32 vcc, 0, v124
    v_add_f32 v76, v72, v74
    v_add_f32 v77, v73, v75
    v_fma_f32 v76, v76, v33, v31
    v_fma_f32 v77, v77, v33, v32
    v_cvt_pk_bf16_f32 v76, v76, v77
    ds_write_b32 v17, v76
    s_cbranch_vccnz S1_s2poll
    s_waitcnt lgkmcnt(0)
    s_barrier
    ds_read_b128 v[64:67], v18 offset:0
    ds_read_b128 v[68:71], v18 offset:64
    s_waitcnt lgkmcnt(1)
    v_smfmac_f32_16x16x64_bf16 v[80:83], v[64:67], v[184:191], v52
    v_smfmac_f32_16x16x64_bf16 v[84:87], v[64:67], v[200:207], v52
    s_waitcnt lgkmcnt(0)
    v_smfmac_f32_16x16x64_bf16 v[80:83], v[68:71], v[192:199], v52
    v_smfmac_f32_16x16x64_bf16 v[84:87], v[68:71], v[208:215], v52
    s_nop 6
    v_add_f32 v72, v80, v81
    v_add_f32 v73, v84, v85
    v_exp_f32 v74, v72
    v_exp_f32 v75, v73
    v_max_f32 v76, |v72|, |v73|
    v_cvt_pk_bf16_f32 v74, v74, v75
    v_cmp_nge_f32 vcc, s65, v76
    ds_write_b32 v19, v74
    s_cbranch_vccnz S1_mx
S1_mxr:
    s_waitcnt lgkmcnt(0)
    s_barrier
    ds_read_b128 v[64:67], v53 offset:0
    ds_read_b128 v[68:71], v53 offset:128
    ds_read_b128 v[72:75], v21 offset:64
    s_waitcnt lgkmcnt(2)
    v_smfmac_f32_16x16x64_bf16 v[88:91], v[64:67], v[112:119], v52
    v_smfmac_f32_16x16x64_bf16 v[96:99], v[64:67], v[216:223], v52
    s_waitcnt lgkmcnt(0)
    v_smfmac_f32_16x16x64_bf16 v[88:91], v[68:71], v[112:119], v52
    v_or3_b32 v78, v72, v73, v74
    v_smfmac_f32_16x16x64_bf16 v[100:103], v[64:67], v[224:231], v52
    v_or_b32 v78, v78, v75
    v_smfmac_f32_16x16x64_bf16 v[96:99], v[68:71], v[232:239], v52
    v_cmp_ne_u32 vcc, 0, v78
    v_smfmac_f32_16x16x64_bf16 v[100:103], v[68:71], v[240:247], v52
    s_nop 1
    v_add_f32 v121, v88, v89
    s_cbranch_vccnz S1_pv
    buffer_store_dwordx4 v[120:123], v9, s[44:47], 0 offen sc1
    s_nop 0
    v_add_f32 v76, v96, v97
    s_nop 0
    v_add_f32 v77, v100, v101
S1_pvr:
    v_cvt_pk_bf16_f32 v76, v76, v77
    v_min_u32 v76, -2, v76
    buffer_store_dword v76, v10, s[44:47], 0 offen sc1
S1_s3m:
    buffer_load_dwordx3 v[64:66], v11, s[44:47], 0 offen sc1
    s_sub_u32 s8, s8, 1
    s_cbranch_scc1 L_end
    s_waitcnt vmcnt(0)
    v_cmp_ne_u32 vcc, s6, v66
    s_cbranch_vccnz S1_s3m
    buffer_load_dwordx4 v[68:71], v12, s[44:47], 0 offen sc1
    buffer_load_dwordx4 v[72:75], v12, s[44:47], 0 offen offset:1024 sc1
    v_max_f32_dpp v84, v64, v64 quad_perm:[1,0,3,2] row_mask:0xf bank_mask:0xf
    s_nop 1
    v_max_f32_dpp v84, v84, v84 quad_perm:[2,3,0,1] row_mask:0xf bank_mask:0xf
    s_nop 1
    v_max_f32_dpp v84, v84, v84 row_half_mirror row_mask:0xf bank_mask:0xf
    v_sub_f32 v84, v64, v84
    v_exp_f32 v84, v84
    s_nop 0
    v_cvt_pk_bf16_f32 v84, v84, v84
    v_and_b32 v85, 0xffff0000, v84
    s_nop 0
    v_and_b32_dpp v88, v84, v48 row_newbcast:0 row_mask:0xf bank_mask:0xf
    v_and_b32_dpp v89, v84, v49 row_newbcast:0 row_mask:0xf bank_mask:0xf
    v_and_b32_dpp v90, v84, v50 row_newbcast:0 row_mask:0xf bank_mask:0xf
    v_and_b32_dpp v91, v84, v51 row_newbcast:0 row_mask:0xf bank_mask:0xf
    v_mul_f32 v85, v85, v65
    v_and_b32_dpp v92, v84, v48 row_newbcast:4 row_mask:0xf bank_mask:0xf
    v_and_b32_dpp v93, v84, v49 row_newbcast:4 row_mask:0xf bank_mask:0xf
    v_add_f32_dpp v85, v85, v85 quad_perm:[1,0,3,2] row_mask:0xf bank_mask:0xf
    v_and_b32_dpp v94, v84, v50 row_newbcast:4 row_mask:0xf bank_mask:0xf
    v_and_b32_dpp v95, v84, v51 row_newbcast:4 row_mask:0xf bank_mask:0xf
    v_add_f32_dpp v85, v85, v85 quad_perm:[2,3,0,1] row_mask:0xf bank_mask:0xf
    v_mov_b32 v87, v85
    s_branch S1_s3w
S1_s3poll:
    buffer_load_dwordx4 v[68:71], v12, s[44:47], 0 offen sc1
    buffer_load_dwordx4 v[72:75], v12, s[44:47], 0 offen offset:1024 sc1
    s_sub_u32 s8, s8, 1
    s_cbranch_scc1 L_end
    v_mov_b32 v85, v87
S1_s3w:
    s_waitcnt vmcnt(1)
    v_mfma_f32_16x16x32_bf16 v[80:83], v[88:91], v[68:71], 0
    v_add_f32_dpp v85, v85, v85 row_half_mirror row_mask:0xf bank_mask:0xf
    v_max3_u32 v86, v68, v69, v70
    s_waitcnt vmcnt(0)
    v_mfma_f32_16x16x32_bf16 v[80:83], v[92:95], v[72:75], v[80:83]
    v_rcp_f32 v85, v85
    v_max3_u32 v76, v71, v72, v73
    v_max3_u32 v86, v86, v74, v75
    v_max_u32 v86, v86, v76
    v_cmp_eq_u32 vcc, -1, v86
    s_nop 2
    v_mul_f32 v80, v80, v85
    v_mul_f32 v81, v81, v85
    v_cvt_pk_bf16_f32 v80, v80, v81
    ds_write_b32 v54, v80
    s_cbranch_vccnz S1_s3poll
    s_waitcnt lgkmcnt(0)
    s_barrier
    ds_read_b128 v[64:67], v22 offset:0
    ds_read_b128 v[68:71], v22 offset:64
    ds_read_b128 v[72:75], v22 offset:128
    ds_read_b128 v[76:79], v22 offset:192
    s_mov_b32 s56, 0x80000
    s_waitcnt lgkmcnt(3)
    v_mfma_f32_16x16x32_bf16 v[80:83], v[64:67], v[160:163], 0
    s_waitcnt lgkmcnt(2)
    v_mfma_f32_16x16x32_bf16 v[80:83], v[68:71], v[164:167], v[80:83]
    s_waitcnt lgkmcnt(1)
    v_mfma_f32_16x16x32_bf16 v[80:83], v[72:75], v[168:171], v[80:83]
    s_waitcnt lgkmcnt(0)
    v_mfma_f32_16x16x32_bf16 v[80:83], v[76:79], v[172:175], v[80:83]
    s_nop 7
    v_cvt_pk_bf16_f32 v84, v80, v81
    v_cvt_pk_bf16_f32 v85, v82, v83
    v_min_u32 v84, -2, v84
    v_min_u32 v85, -2, v85
    buffer_store_dwordx2 v[84:85], v252, s[40:43], s56 offen sc1
    s_mov_b32 s58, 0xd000
    s_cmp_lg_u32 s5, 0
    s_cbranch_scc1 S1_s4_oth
    s_and_b32 s56, s50, 1
    s_lshl_b32 s56, s56, 14
    s_add_u32 s56, s56, 0x80000
    s_sleep 8
S1_s4:
    buffer_load_dwordx4 v[64:67], v253, s[40:43], s56 offen offset:0 sc1
    buffer_load_dwordx4 v[68:71], v253, s[40:43], s56 offen offset:1024 sc1
    buffer_load_dwordx4 v[72:75], v253, s[40:43], s56 offen offset:2048 sc1
    buffer_load_dwordx4 v[76:79], v253, s[40:43], s56 offen offset:3072 sc1
    s_sub_u32 s8, s8, 1
    s_cbranch_scc1 L_end
    s_waitcnt vmcnt(3)
    v_mfma_f32_16x16x32_bf16 v[80:83], v[248:251], v[64:67], 0
    v_max3_u32 v84, v64, v65, v66
    v_mov_b32 v85, v67
    s_waitcnt vmcnt(2)
    v_mfma_f32_16x16x32_bf16 v[80:83], v[248:251], v[68:71], v[80:83]
    v_max3_u32 v84, v84, v68, v69
    v_max3_u32 v85, v85, v70, v71
    s_waitcnt vmcnt(1)
    v_mfma_f32_16x16x32_bf16 v[80:83], v[248:251], v[72:75], v[80:83]
    v_max3_u32 v84, v84, v72, v73
    v_max3_u32 v85, v85, v74, v75
    s_waitcnt vmcnt(0)
    v_mfma_f32_16x16x32_bf16 v[80:83], v[248:251], v[76:79], v[80:83]
    v_max3_u32 v84, v84, v76, v77
    v_max3_u32 v85, v85, v78, v79
    v_max_u32 v84, v84, v85
    v_cmp_eq_u32 vcc, -1, v84
    s_nop 3
    v_add_f32_dpp v80, v80, v80 row_ror:8 row_mask:0xf bank_mask:0xf
    v_add_f32_dpp v81, v81, v81 row_ror:8 row_mask:0xf bank_mask:0xf
    s_cbranch_vccnz S1_s4
    v_cvt_pk_bf16_f32 v80, v80, v81
    v_and_b32 v81, 0xffff0000, v80
    v_lshlrev_b32 v80, 16, v80
    v_add_f32 v81, v81, v30
    v_add_f32 v80, v80, v255
    v_cvt_pk_bf16_f32 v80, v80, v81
    v_min_u32 v81, -2, v80
    buffer_store_dword v81, v254, s[44:47], s58 offen sc1
    v_lshlrev_b32 v255, 16, v80
    v_and_b32 v30, 0xffff0000, v80
S1_s4_oth:
    s_nop 15
    s_barrier
    buffer_load_dwordx4 v[34:37], v2, s[44:47], s58 offen sc1
    s_nop 15
    buffer_load_dwordx4 v[34:37], v2, s[44:47], s58 offen sc1
    s_nop 15
S1_s5:
    buffer_load_dwordx4 v[34:37], v2, s[44:47], s58 offen sc1
    s_sub_u32 s8, s8, 1
    s_cbranch_scc1 L_end
    s_waitcnt vmcnt(2)
    v_max3_u32 v72, v34, v35, v36
    v_max_u32 v72, v72, v37
    v_mfma_f32_16x16x32_bf16 v[80:83], v[144:147], v[34:37], 0
    v_cmp_eq_u32 vcc, -1, v72
    v_mfma_f32_16x16x32_bf16 v[84:87], v[148:151], v[34:37], 0
    v_mfma_f32_16x16x32_bf16 v[88:91], v[152:155], v[34:37], 0
    s_cbranch_vccnz S1_s5
    v_mfma_f32_16x16x32_bf16 v[92:95], v[156:159], v[34:37], 0
    buffer_load_dwordx4 v[74:77], v4, s[44:47], s58 offen sc1
    s_nop 3
    v_add_f32_dpp v80, v84, v80 quad_perm:[1,1,1,1] row_mask:0xf bank_mask:0xf
    v_add_f32_dpp v81, v85, v81 quad_perm:[1,1,1,1] row_mask:0xf bank_mask:0xf
    v_add_f32_dpp v82, v86, v82 quad_perm:[1,1,1,1] row_mask:0xf bank_mask:0xf
    v_add_f32_dpp v83, v87, v83 quad_perm:[1,1,1,1] row_mask:0xf bank_mask:0xf
    v_add_f32_dpp v80, v88, v80 quad_perm:[2,2,2,2] row_mask:0xf bank_mask:0xf
    v_add_f32_dpp v81, v89, v81 quad_perm:[2,2,2,2] row_mask:0xf bank_mask:0xf
    v_add_f32_dpp v82, v90, v82 quad_perm:[2,2,2,2] row_mask:0xf bank_mask:0xf
    v_add_f32_dpp v83, v91, v83 quad_perm:[2,2,2,2] row_mask:0xf bank_mask:0xf
    v_add_f32_dpp v80, v92, v80 quad_perm:[3,3,3,3] row_mask:0xf bank_mask:0xf
    v_add_f32_dpp v81, v93, v81 quad_perm:[3,3,3,3] row_mask:0xf bank_mask:0xf
    v_add_f32_dpp v82, v94, v82 quad_perm:[3,3,3,3] row_mask:0xf bank_mask:0xf
    v_add_f32_dpp v83, v95, v83 quad_perm:[3,3,3,3] row_mask:0xf bank_mask:0xf
    v_bfi_b32 v80, s12, v25, v80
    v_bfi_b32 v81, s12, v25, v81
    v_bfi_b32 v82, s12, v25, v82
    v_bfi_b32 v83, s12, v25, v83
    buffer_store_dwordx4 v[80:83], v6, s[44:47], 0 offen sc1
    s_waitcnt vmcnt(1)
    s_branch S1_s6st_c
S1_s6st:
    buffer_load_dwordx4 v[74:77], v4, s[44:47], s58 offen sc1
    s_sub_u32 s8, s8, 1
    s_cbranch_scc1 L_end
    s_waitcnt vmcnt(0)
S1_s6st_c:
    v_max3_u32 v96, v74, v75, v76
    v_max_u32 v96, v96, v77
    v_cmp_eq_u32 vcc, -1, v96
    s_cbranch_vccnz S1_s6st
    v_dot2_f32_bf16 v96, v74, s51, 0
    v_dot2_f32_bf16 v97, v74, v74, 0
    v_dot2_f32_bf16 v96, v75, s51, v96
    v_dot2_f32_bf16 v97, v75, v75, v97
    v_dot2_f32_bf16 v96, v76, s51, v96
    v_dot2_f32_bf16 v97, v76, v76, v97
    v_dot2_f32_bf16 v96, v77, s51, v96
    v_dot2_f32_bf16 v97, v77, v77, v97
    v_mov_b32 v98, 0x3b000000
    buffer_load_dwordx4 v[38:41], v8, s[44:47], 0 offen sc1
    buffer_load_dwordx4 v[42:45], v8, s[44:47], 0 offen offset:256 sc1
    v_add_f32_dpp v96, v96, v96 quad_perm:[1,0,3,2] row_mask:0xf bank_mask:0xf
    v_add_f32_dpp v97, v97, v97 quad_perm:[1,0,3,2] row_mask:0xf bank_mask:0xf
    s_nop 0
    v_add_f32_dpp v96, v96, v96 quad_perm:[2,3,0,1] row_mask:0xf bank_mask:0xf
    v_add_f32_dpp v97, v97, v97 quad_perm:[2,3,0,1] row_mask:0xf bank_mask:0xf
    s_nop 0
    v_add_f32_dpp v96, v96, v96 row_half_mirror row_mask:0xf bank_mask:0xf
    v_add_f32_dpp v97, v97, v97 row_half_mirror row_mask:0xf bank_mask:0xf
    s_nop 0
    v_add_f32_dpp v96, v96, v96 row_mirror row_mask:0xf bank_mask:0xf
    v_add_f32_dpp v97, v97, v97 row_mirror row_mask:0xf bank_mask:0xf
    s_nop 0
    v_add_f32_dpp v96, v96, v96 row_bcast:15 row_mask:0xa bank_mask:0xf
    v_add_f32_dpp v97, v97, v97 row_bcast:15 row_mask:0xa bank_mask:0xf
    s_nop 0
    v_add_f32_dpp v96, v96, v96 row_bcast:31 row_mask:0xc bank_mask:0xf
    v_add_f32_dpp v97, v97, v97 row_bcast:31 row_mask:0xc bank_mask:0xf
    v_readlane_b32 s9, v96, 63
    v_readlane_b32 s10, v97, 63
    s_nop 0
    v_mul_f32 v96, s9, v98
    v_mul_f32 v97, s10, v98
    v_fma_f32 v97, -v96, v96, v97
    v_max_f32 v97, 0, v97
    v_add_f32 v97, 0x3727c5ac, v97
    v_rsq_f32 v33, v97
    s_nop 0
    v_mul_f32 v78, -v96, v33
    v_mul_f32 v31, v78, v28
    v_mul_f32 v32, v78, v29
    v_mul_f32 v94, 0xbfb8aa3b, v33
    v_mul_f32 v95, 0xbfb8aa3b, v31
    s_mov_b32 s56, 0x100000
    s_mov_b64 vcc, -1
S1_s6poll:
    s_mov_b64 exec, vcc
    buffer_load_dwordx4 v[38:41], v8, s[44:47], 0 offen sc1
    buffer_load_dwordx4 v[42:45], v8, s[44:47], 0 offen offset:256 sc1
    s_mov_b64 exec, -1
    s_sub_u32 s8, s8, 1
    s_cbranch_scc1 L_end
    s_waitcnt vmcnt(2)
    v_bitop3_b32 v80, v38, v39, s6 bitop3:0x7e
    v_bitop3_b32 v81, v40, v41, s6 bitop3:0x7e
    v_bitop3_b32 v82, v42, v43, s6 bitop3:0x7e
    v_bitop3_b32 v83, v44, v45, s6 bitop3:0x7e
    v_pk_add_f32 v[72:73], v[38:39], v[42:43]
    v_pk_add_f32 v[74:75], v[40:41], v[44:45]
    v_or3_b32 v80, v80, v81, v82
    v_bitop3_b32 v80, v80, v83, s12 bitop3:0xa8
    v_permlane16_swap_b32 v72, v74
    v_permlane16_swap_b32 v73, v75
    v_cmp_ne_u32 vcc, 0, v80
    v_add_f32 v72, v72, v74
    v_add_f32 v74, v73, v75
    s_nop 1
    v_permlane32_swap_b32 v72, v74
    v_fma_f32 v73, v72, v94, v95
    s_cbranch_vccnz S1_s6poll
    v_exp_f32 v73, v73
    v_fma_f32 v72, v72, v33, v31
    v_add_f32 v73, 1.0, v73
    v_fma_f32 v74, v74, v33, v32
    v_rcp_f32 v73, v73
    v_mul_f32 v74, v74, v72
    v_mul_f32 v72, v74, v73
    v_cvt_pk_bf16_f32 v72, v72, v72
    ds_write_b16 v23, v72
    s_waitcnt lgkmcnt(0)
    s_barrier
    ds_read_b128 v[64:67], v24 offset:0
    ds_read_b128 v[68:71], v24 offset:64
    s_waitcnt lgkmcnt(1)
    v_mfma_f32_16x16x32_bf16 v[80:83], v[64:67], v[176:179], 0
    s_waitcnt lgkmcnt(0)
    v_mfma_f32_16x16x32_bf16 v[80:83], v[68:71], v[180:183], v[80:83]
    s_nop 7
    v_cvt_pk_bf16_f32 v84, v80, v81
    v_cvt_pk_bf16_f32 v85, v82, v83
    v_min_u32 v84, -2, v84
    v_min_u32 v85, -2, v85
    buffer_store_dwordx2 v[84:85], v14, s[40:43], s56 offen sc1
    s_cmp_lg_u32 s52, 0
    s_cbranch_scc1 L_finish2
    s_cmp_lg_u32 s5, 0
    s_cbranch_scc1 L_finish2
    s_mov_b32 s56, 0x100000
    s_sleep 8
S1_s7:
    buffer_load_dwordx4 v[64:67], v253, s[40:43], s56 offen offset:0 sc1
    buffer_load_dwordx4 v[68:71], v253, s[40:43], s56 offen offset:1024 sc1
    buffer_load_dwordx4 v[72:75], v253, s[40:43], s56 offen offset:2048 sc1
    buffer_load_dwordx4 v[76:79], v253, s[40:43], s56 offen offset:3072 sc1
    s_sub_u32 s8, s8, 1
    s_cbranch_scc1 L_end
    s_waitcnt vmcnt(3)
    v_mfma_f32_16x16x32_bf16 v[80:83], v[248:251], v[64:67], 0
    v_max3_u32 v84, v64, v65, v66
    v_mov_b32 v85, v67
    s_waitcnt vmcnt(2)
    v_mfma_f32_16x16x32_bf16 v[80:83], v[248:251], v[68:71], v[80:83]
    v_max3_u32 v84, v84, v68, v69
    v_max3_u32 v85, v85, v70, v71
    s_waitcnt vmcnt(1)
    v_mfma_f32_16x16x32_bf16 v[80:83], v[248:251], v[72:75], v[80:83]
    v_max3_u32 v84, v84, v72, v73
    v_max3_u32 v85, v85, v74, v75
    s_waitcnt vmcnt(0)
    v_mfma_f32_16x16x32_bf16 v[80:83], v[248:251], v[76:79], v[80:83]
    v_max3_u32 v84, v84, v76, v77
    v_max3_u32 v85, v85, v78, v79
    v_max_u32 v84, v84, v85
    v_cmp_eq_u32 vcc, -1, v84
    s_nop 3
    v_add_f32_dpp v80, v80, v80 row_ror:8 row_mask:0xf bank_mask:0xf
    v_add_f32_dpp v81, v81, v81 row_ror:8 row_mask:0xf bank_mask:0xf
    s_cbranch_vccnz S1_s7
    v_cvt_pk_bf16_f32 v80, v80, v81
    v_and_b32 v81, 0xffff0000, v80
    v_lshlrev_b32 v80, 16, v80
    v_add_f32 v81, v81, v30
    v_add_f32 v80, v80, v255
    v_cvt_pk_bf16_f32 v80, v80, v81
    buffer_store_dword v80, v254, s[16:19], 0 offen
    s_branch L_finish
    s_nop 7
F0_mx:
    v_max_f32 v74, v72, v73
    s_nop 1
    v_max_f32_dpp v74, v74, v74 quad_perm:[1,0,3,2] row_mask:0xf bank_mask:0xf
    s_nop 1
    v_max_f32_dpp v74, v74, v74 quad_perm:[2,3,0,1] row_mask:0xf bank_mask:0xf
    s_nop 1
    v_max_f32_dpp v74, v74, v74 row_half_mirror row_mask:0xf bank_mask:0xf
    s_nop 1
    v_max_f32_dpp v74, v74, v74 row_mirror row_mask:0xf bank_mask:0xf
    v_sub_f32 v72, v72, v74
    v_sub_f32 v73, v73, v74
    ds_write_b32 v20, v74 offset:0
    v_exp_f32 v72, v72
    v_exp_f32 v73, v73
    s_nop 0
    v_cvt_pk_bf16_f32 v72, v72, v73
    ds_write_b32 v19, v72
    s_branch F0_mxr
    s_nop 7
F0_pv:
    s_nop 7
    v_mov_b64 v[88:89], 0
    v_mov_b64 v[92:93], 0
    v_mov_b64 v[96:97], 0
    v_mov_b64 v[100:101], 0
    v_mov_b64 v[104:105], 0
    v_mov_b64 v[108:109], 0
    v_max3_f32 v120, v72, v73, v74
    v_max_f32 v120, v120, v75
    v_smfmac_f32_16x16x64_bf16 v[88:91], v[64:67], v[112:119], v52
    v_smfmac_f32_16x16x64_bf16 v[92:95], v[68:71], v[112:119], v52
    v_smfmac_f32_16x16x64_bf16 v[96:99], v[64:67], v[216:223], v52
    v_smfmac_f32_16x16x64_bf16 v[100:103], v[64:67], v[224:231], v52
    v_smfmac_f32_16x16x64_bf16 v[104:107], v[68:71], v[232:239], v52
    v_smfmac_f32_16x16x64_bf16 v[108:111], v[68:71], v[240:247], v52
    v_sub_f32 v72, v72, v120
    v_sub_f32 v73, v73, v120
    v_sub_f32 v74, v74, v120
    v_sub_f32 v75, v75, v120
    v_exp_f32 v72, v72
    v_exp_f32 v73, v73
    v_exp_f32 v74, v74
    v_exp_f32 v75, v75
    v_mul_f32 v121, v88, v72
    v_mul_f32 v76, v96, v72
    v_mul_f32 v77, v100, v72
    v_fmac_f32 v121, v89, v73
    v_fmac_f32 v76, v97, v73
    v_fmac_f32 v77, v101, v73
    v_fmac_f32 v121, v92, v74
    v_fmac_f32 v76, v104, v74
    v_fmac_f32 v77, v108, v74
    v_fmac_f32 v121, v93, v75
    v_fmac_f32 v76, v105, v75
    v_fmac_f32 v77, v109, v75
    buffer_store_dwordx4 v[120:123], v9, s[44:47], 0 offen
    s_branch F0_pvr
    s_nop 7
F0_wg:
    v_max_f32_dpp v84, v64, v64 quad_perm:[1,0,3,2] row_mask:0xf bank_mask:0xf
    s_nop 1
    v_max_f32_dpp v84, v84, v84 quad_perm:[2,3,0,1] row_mask:0xf bank_mask:0xf
    s_nop 1
    v_max_f32_dpp v84, v84, v84 row_half_mirror row_mask:0xf bank_mask:0xf
    v_sub_f32 v84, v64, v84
    v_exp_f32 v84, v84
    s_nop 0
    v_cvt_pk_bf16_f32 v84, v84, v84
    v_and_b32 v85, 0xffff0000, v84
    s_nop 0
    v_and_b32_dpp v88, v84, v48 row_newbcast:0 row_mask:0xf bank_mask:0xf
    v_and_b32_dpp v89, v84, v49 row_newbcast:0 row_mask:0xf bank_mask:0xf
    v_and_b32_dpp v90, v84, v50 row_newbcast:0 row_mask:0xf bank_mask:0xf
    v_and_b32_dpp v91, v84, v51 row_newbcast:0 row_mask:0xf bank_mask:0xf
    v_mul_f32 v85, v85, v65
    v_and_b32_dpp v92, v84, v48 row_newbcast:4 row_mask:0xf bank_mask:0xf
    v_and_b32_dpp v93, v84, v49 row_newbcast:4 row_mask:0xf bank_mask:0xf
    v_add_f32_dpp v85, v85, v85 quad_perm:[1,0,3,2] row_mask:0xf bank_mask:0xf
    v_and_b32_dpp v94, v84, v50 row_newbcast:4 row_mask:0xf bank_mask:0xf
    v_and_b32_dpp v95, v84, v51 row_newbcast:4 row_mask:0xf bank_mask:0xf
    v_add_f32_dpp v85, v85, v85 quad_perm:[2,3,0,1] row_mask:0xf bank_mask:0xf
    s_nop 1
    v_add_f32_dpp v85, v85, v85 row_half_mirror row_mask:0xf bank_mask:0xf
    v_mfma_f32_16x16x32_bf16 v[80:83], v[88:91], v[38:41], 0
    v_mfma_f32_16x16x32_bf16 v[80:83], v[92:95], v[42:45], v[80:83]
    v_rcp_f32 v85, v85
    s_nop 6
    v_mul_f32 v80, v80, v85
    v_mul_f32 v81, v81, v85
    v_cvt_pk_bf16_f32 v80, v80, v81
    ds_write_b32 v54, v80
    s_branch F0_wgr
    s_nop 7
F0_qcr:
    buffer_load_dwordx4 v[104:107], v7, s[44:47], s57 offen sc1
    buffer_load_dwordx4 v[108:111], v7, s[44:47], s57 offen offset:2048 sc1
    s_sub_u32 s8, s8, 1
    s_cbranch_scc1 L_end
    s_branch F0_qcw
    s_nop 7
F1_mx:
    v_max_f32 v74, v72, v73
    s_nop 1
    v_max_f32_dpp v74, v74, v74 quad_perm:[1,0,3,2] row_mask:0xf bank_mask:0xf
    s_nop 1
    v_max_f32_dpp v74, v74, v74 quad_perm:[2,3,0,1] row_mask:0xf bank_mask:0xf
    s_nop 1
    v_max_f32_dpp v74, v74, v74 row_half_mirror row_mask:0xf bank_mask:0xf
    s_nop 1
    v_max_f32_dpp v74, v74, v74 row_mirror row_mask:0xf bank_mask:0xf
    v_sub_f32 v72, v72, v74
    v_sub_f32 v73, v73, v74
    ds_write_b32 v20, v74 offset:64
    v_exp_f32 v72, v72
    v_exp_f32 v73, v73
    s_nop 0
    v_cvt_pk_bf16_f32 v72, v72, v73
    ds_write_b32 v19, v72
    s_branch F1_mxr
    s_nop 7
F1_pv:
    s_nop 7
    v_mov_b64 v[88:89], 0
    v_mov_b64 v[92:93], 0
    v_mov_b64 v[96:97], 0
    v_mov_b64 v[100:101], 0
    v_mov_b64 v[104:105], 0
    v_mov_b64 v[108:109], 0
    v_max3_f32 v120, v72, v73, v74
    v_max_f32 v120, v120, v75
    v_smfmac_f32_16x16x64_bf16 v[88:91], v[64:67], v[112:119], v52
    v_smfmac_f32_16x16x64_bf16 v[92:95], v[68:71], v[112:119], v52
    v_smfmac_f32_16x16x64_bf16 v[96:99], v[64:67], v[216:223], v52
    v_smfmac_f32_16x16x64_bf16 v[100:103], v[64:67], v[224:231], v52
    v_smfmac_f32_16x16x64_bf16 v[104:107], v[68:71], v[232:239], v52
    v_smfmac_f32_16x16x64_bf16 v[108:111], v[68:71], v[240:247], v52
    v_sub_f32 v72, v72, v120
    v_sub_f32 v73, v73, v120
    v_sub_f32 v74, v74, v120
    v_sub_f32 v75, v75, v120
    v_exp_f32 v72, v72
    v_exp_f32 v73, v73
    v_exp_f32 v74, v74
    v_exp_f32 v75, v75
    v_mul_f32 v121, v88, v72
    v_mul_f32 v76, v96, v72
    v_mul_f32 v77, v100, v72
    v_fmac_f32 v121, v89, v73
    v_fmac_f32 v76, v97, v73
    v_fmac_f32 v77, v101, v73
    v_fmac_f32 v121, v92, v74
    v_fmac_f32 v76, v104, v74
    v_fmac_f32 v77, v108, v74
    v_fmac_f32 v121, v93, v75
    v_fmac_f32 v76, v105, v75
    v_fmac_f32 v77, v109, v75
    buffer_store_dwordx4 v[120:123], v9, s[44:47], 0 offen
    s_branch F1_pvr
    s_nop 7
F1_wg:
    v_max_f32_dpp v84, v64, v64 quad_perm:[1,0,3,2] row_mask:0xf bank_mask:0xf
    s_nop 1
    v_max_f32_dpp v84, v84, v84 quad_perm:[2,3,0,1] row_mask:0xf bank_mask:0xf
    s_nop 1
    v_max_f32_dpp v84, v84, v84 row_half_mirror row_mask:0xf bank_mask:0xf
    v_sub_f32 v84, v64, v84
    v_exp_f32 v84, v84
    s_nop 0
    v_cvt_pk_bf16_f32 v84, v84, v84
    v_and_b32 v85, 0xffff0000, v84
    s_nop 0
    v_and_b32_dpp v88, v84, v48 row_newbcast:0 row_mask:0xf bank_mask:0xf
    v_and_b32_dpp v89, v84, v49 row_newbcast:0 row_mask:0xf bank_mask:0xf
    v_and_b32_dpp v90, v84, v50 row_newbcast:0 row_mask:0xf bank_mask:0xf
    v_and_b32_dpp v91, v84, v51 row_newbcast:0 row_mask:0xf bank_mask:0xf
    v_mul_f32 v85, v85, v65
    v_and_b32_dpp v92, v84, v48 row_newbcast:4 row_mask:0xf bank_mask:0xf
    v_and_b32_dpp v93, v84, v49 row_newbcast:4 row_mask:0xf bank_mask:0xf
    v_add_f32_dpp v85, v85, v85 quad_perm:[1,0,3,2] row_mask:0xf bank_mask:0xf
    v_and_b32_dpp v94, v84, v50 row_newbcast:4 row_mask:0xf bank_mask:0xf
    v_and_b32_dpp v95, v84, v51 row_newbcast:4 row_mask:0xf bank_mask:0xf
    v_add_f32_dpp v85, v85, v85 quad_perm:[2,3,0,1] row_mask:0xf bank_mask:0xf
    s_nop 1
    v_add_f32_dpp v85, v85, v85 row_half_mirror row_mask:0xf bank_mask:0xf
    v_mfma_f32_16x16x32_bf16 v[80:83], v[88:91], v[38:41], 0
    v_mfma_f32_16x16x32_bf16 v[80:83], v[92:95], v[42:45], v[80:83]
    v_rcp_f32 v85, v85
    s_nop 6
    v_mul_f32 v80, v80, v85
    v_mul_f32 v81, v81, v85
    v_cvt_pk_bf16_f32 v80, v80, v81
    ds_write_b32 v54, v80
    s_branch F1_wgr
    s_nop 7
S0_mx:
    v_max_f32 v74, v72, v73
    s_nop 1
    v_max_f32_dpp v74, v74, v74 quad_perm:[1,0,3,2] row_mask:0xf bank_mask:0xf
    s_nop 1
    v_max_f32_dpp v74, v74, v74 quad_perm:[2,3,0,1] row_mask:0xf bank_mask:0xf
    s_nop 1
    v_max_f32_dpp v74, v74, v74 row_half_mirror row_mask:0xf bank_mask:0xf
    s_nop 1
    v_max_f32_dpp v74, v74, v74 row_mirror row_mask:0xf bank_mask:0xf
    v_sub_f32 v72, v72, v74
    v_sub_f32 v73, v73, v74
    ds_write_b32 v20, v74 offset:0
    v_exp_f32 v72, v72
    v_exp_f32 v73, v73
    s_nop 0
    v_cvt_pk_bf16_f32 v72, v72, v73
    ds_write_b32 v19, v72
    s_branch S0_mxr
    s_nop 7
S0_pv:
    s_nop 7
    v_mov_b64 v[88:89], 0
    v_mov_b64 v[92:93], 0
    v_mov_b64 v[96:97], 0
    v_mov_b64 v[100:101], 0
    v_mov_b64 v[104:105], 0
    v_mov_b64 v[108:109], 0
    v_max3_f32 v120, v72, v73, v74
    v_max_f32 v120, v120, v75
    v_smfmac_f32_16x16x64_bf16 v[88:91], v[64:67], v[112:119], v52
    v_smfmac_f32_16x16x64_bf16 v[92:95], v[68:71], v[112:119], v52
    v_smfmac_f32_16x16x64_bf16 v[96:99], v[64:67], v[216:223], v52
    v_smfmac_f32_16x16x64_bf16 v[100:103], v[64:67], v[224:231], v52
    v_smfmac_f32_16x16x64_bf16 v[104:107], v[68:71], v[232:239], v52
    v_smfmac_f32_16x16x64_bf16 v[108:111], v[68:71], v[240:247], v52
    v_sub_f32 v72, v72, v120
    v_sub_f32 v73, v73, v120
    v_sub_f32 v74, v74, v120
    v_sub_f32 v75, v75, v120
    v_exp_f32 v72, v72
    v_exp_f32 v73, v73
    v_exp_f32 v74, v74
    v_exp_f32 v75, v75
    v_mul_f32 v121, v88, v72
    v_mul_f32 v76, v96, v72
    v_mul_f32 v77, v100, v72
    v_fmac_f32 v121, v89, v73
    v_fmac_f32 v76, v97, v73
    v_fmac_f32 v77, v101, v73
    v_fmac_f32 v121, v92, v74
    v_fmac_f32 v76, v104, v74
    v_fmac_f32 v77, v108, v74
    v_fmac_f32 v121, v93, v75
    v_fmac_f32 v76, v105, v75
    v_fmac_f32 v77, v109, v75
    buffer_store_dwordx4 v[120:123], v9, s[44:47], 0 offen sc1
    s_branch S0_pvr
    s_nop 7
S0_l13:
S0_s13:
    s_mov_b64 exec, 1
    ds_read_b32 v64, v59 offset:16
    s_mov_b64 exec, -1
    s_sub_u32 s8, s8, 1
    s_cbranch_scc1 L_end
    s_waitcnt lgkmcnt(0)
    v_readfirstlane_b32 s9, v64
    s_cmp_lt_u32 s9, 6
    s_cbranch_scc1 S0_s13
    ds_read_b64_tr_b16 v[144:145], v56 offset:32768
    ds_read_b64_tr_b16 v[146:147], v56 offset:33280
    ds_read_b64_tr_b16 v[148:149], v56 offset:33792
    ds_read_b64_tr_b16 v[150:151], v56 offset:34304
    ds_read_b64_tr_b16 v[152:153], v56 offset:34816
    ds_read_b64_tr_b16 v[154:155], v56 offset:35328
    ds_read_b64_tr_b16 v[156:157], v56 offset:35840
    ds_read_b64_tr_b16 v[158:159], v56 offset:36352
    v_mov_b32 v100, s51
    v_mov_b32 v101, s51
    v_mov_b32 v102, s51
    v_mov_b32 v103, s51
    s_waitcnt lgkmcnt(0)
    s_nop 0
    v_mfma_f32_16x16x32_bf16 v[96:99], v[144:147], v[100:103], 0
    v_mfma_f32_16x16x32_bf16 v[96:99], v[148:151], v[100:103], v[96:99]
    v_mfma_f32_16x16x32_bf16 v[96:99], v[152:155], v[100:103], v[96:99]
    v_mfma_f32_16x16x32_bf16 v[96:99], v[156:159], v[100:103], v[96:99]
    s_nop 7
    v_bfi_b32 v96, s12, v25, v96
    v_bfi_b32 v97, s12, v25, v97
    v_bfi_b32 v98, s12, v25, v98
    v_bfi_b32 v99, s12, v25, v99
    buffer_store_dwordx4 v[96:99], v46, s[44:47], 0 offen sc1
    s_branch S0_l13r
    s_nop 7
S0_qcr:
    buffer_load_dwordx4 v[104:107], v7, s[44:47], s57 offen sc1
    buffer_load_dwordx4 v[108:111], v7, s[44:47], s57 offen offset:2048 sc1
    s_sub_u32 s8, s8, 1
    s_cbranch_scc1 L_end
    s_branch S0_qcw
    s_nop 7
S1_mx:
    v_max_f32 v74, v72, v73
    s_nop 1
    v_max_f32_dpp v74, v74, v74 quad_perm:[1,0,3,2] row_mask:0xf bank_mask:0xf
    s_nop 1
    v_max_f32_dpp v74, v74, v74 quad_perm:[2,3,0,1] row_mask:0xf bank_mask:0xf
    s_nop 1
    v_max_f32_dpp v74, v74, v74 row_half_mirror row_mask:0xf bank_mask:0xf
    s_nop 1
    v_max_f32_dpp v74, v74, v74 row_mirror row_mask:0xf bank_mask:0xf
    v_sub_f32 v72, v72, v74
    v_sub_f32 v73, v73, v74
    ds_write_b32 v20, v74 offset:64
    v_exp_f32 v72, v72
    v_exp_f32 v73, v73
    s_nop 0
    v_cvt_pk_bf16_f32 v72, v72, v73
    ds_write_b32 v19, v72
    s_branch S1_mxr
    s_nop 7
S1_pv:
    s_nop 7
    v_mov_b64 v[88:89], 0
    v_mov_b64 v[92:93], 0
    v_mov_b64 v[96:97], 0
    v_mov_b64 v[100:101], 0
    v_mov_b64 v[104:105], 0
    v_mov_b64 v[108:109], 0
    v_max3_f32 v120, v72, v73, v74
    v_max_f32 v120, v120, v75
    v_smfmac_f32_16x16x64_bf16 v[88:91], v[64:67], v[112:119], v52
    v_smfmac_f32_16x16x64_bf16 v[92:95], v[68:71], v[112:119], v52
    v_smfmac_f32_16x16x64_bf16 v[96:99], v[64:67], v[216:223], v52
    v_smfmac_f32_16x16x64_bf16 v[100:103], v[64:67], v[224:231], v52
    v_smfmac_f32_16x16x64_bf16 v[104:107], v[68:71], v[232:239], v52
    v_smfmac_f32_16x16x64_bf16 v[108:111], v[68:71], v[240:247], v52
    v_sub_f32 v72, v72, v120
    v_sub_f32 v73, v73, v120
    v_sub_f32 v74, v74, v120
    v_sub_f32 v75, v75, v120
    v_exp_f32 v72, v72
    v_exp_f32 v73, v73
    v_exp_f32 v74, v74
    v_exp_f32 v75, v75
    v_mul_f32 v121, v88, v72
    v_mul_f32 v76, v96, v72
    v_mul_f32 v77, v100, v72
    v_fmac_f32 v121, v89, v73
    v_fmac_f32 v76, v97, v73
    v_fmac_f32 v77, v101, v73
    v_fmac_f32 v121, v92, v74
    v_fmac_f32 v76, v104, v74
    v_fmac_f32 v77, v108, v74
    v_fmac_f32 v121, v93, v75
    v_fmac_f32 v76, v105, v75
    v_fmac_f32 v77, v109, v75
    buffer_store_dwordx4 v[120:123], v9, s[44:47], 0 offen sc1
    s_branch S1_pvr
.section .rodata,"a"
.p2align 6
.amdhsa_kernel interleave_layers__sliding_block_cached__glu_gated_swiglu__decode_kernel
  .amdhsa_next_free_vgpr 256
  .amdhsa_next_free_sgpr 100
  .amdhsa_accum_offset 256
  .amdhsa_group_segment_fixed_size 0
  .amdhsa_kernarg_size 96
  .amdhsa_user_sgpr_count 2
  .amdhsa_user_sgpr_kernarg_segment_ptr 1
  .amdhsa_system_sgpr_workgroup_id_x 1
  .amdhsa_float_denorm_mode_32 3
.end_amdhsa_kernel
```
